```python
import torch

def _softmax(x, axis=-1):
    return torch.softmax(x, dim=axis)
def _gelu(x):
    return torch.nn.functional.gelu(x, approximate="tanh")
def _silu(x):
    return torch.nn.functional.silu(x)
def _sigmoid(x):
    return torch.sigmoid(x)
def _layernorm(x, axis=-1, eps=1e-5):
    m = x.mean(dim=axis, keepdim=True)
    v = x.var(dim=axis, keepdim=True, unbiased=False)
    return (x - m) / torch.sqrt(v + eps)
def _scatter_add(tgt, idx, src, axis=0):
    return tgt.clone().index_add_(axis, idx, src)
def _segment_sum(src, seg, n):
    out = torch.zeros((n,) + src.shape[1:], dtype=src.dtype)
    return out.index_add_(0, seg, src)
def _pad(x, pw):
    flat = tuple(v for pair in reversed(pw) for v in pair)
    return torch.nn.functional.pad(x, flat)

kernel_name = 'sequential_preLN__ssm_conv_s4__dense_activation_relu__prompt'

def setup_inputs():

    _w = (lambda a: (lambda t: t.to(torch.bfloat16) if t.is_floating_point() else t)(torch.as_tensor(a)))
    def _A_setup():
        B, L, D, N = 1, 2048, 448, 256
        A_re = -(lambda _x: torch.exp(torch.as_tensor(_x)))((lambda *s: torch.randn(*s, dtype=torch.bfloat16) * 3.2)(D, N))
        A_im = torch.pi * (lambda *s: torch.randn(*s, dtype=torch.bfloat16) * 0.05)(D, N)
        B_re = (lambda *s: torch.randn(*s, dtype=torch.bfloat16) * 0.05)(D, N)
        B_im = (lambda *s: torch.randn(*s, dtype=torch.bfloat16) * 0.05)(D, N)
        C_re = (lambda *s: torch.randn(*s, dtype=torch.bfloat16) * 0.05)(D, N)
        C_im = (lambda *s: torch.randn(*s, dtype=torch.bfloat16) * 0.05)(D, N)
        log_dt = (lambda *s: torch.randn(*s, dtype=torch.bfloat16) * 0.05)(D) * 0.5 - 4.0
        Dskip = (lambda *s: torch.randn(*s, dtype=torch.bfloat16) * 0.05)(D)
        return {
            "u": _w((lambda *s: torch.randn(*s, dtype=torch.bfloat16) * 0.05)(B, L, D)),
            "A_re": _w(A_re),
            "A_im": _w(A_im),
            "B_re": _w(B_re),
            "B_im": _w(B_im),
            "C_re": _w(C_re),
            "C_im": _w(C_im),
            "log_dt": _w(log_dt),
            "Dskip": _w(Dskip),
        }
    _A_in = _A_setup()

    def _B_setup():
        B, S, D, Dff = 1, 2048, 448, 1792
        return {
            "x": _w((lambda *s: torch.randn(*s, dtype=torch.bfloat16) * 0.05)(B, S, D)),
            "w1": _w((lambda *s: torch.randn(*s, dtype=torch.bfloat16) * 0.05)(D, Dff)),
            "w2": _w((lambda *s: torch.randn(*s, dtype=torch.bfloat16) * 0.05)(Dff, D)),
        }
    _B_in = _B_setup()

    return {
        "A_u": _A_in["u"],
        "A_A_re": _A_in["A_re"],
        "A_A_im": _A_in["A_im"],
        "A_B_re": _A_in["B_re"],
        "A_B_im": _A_in["B_im"],
        "A_C_re": _A_in["C_re"],
        "A_C_im": _A_in["C_im"],
        "A_log_dt": _A_in["log_dt"],
        "A_Dskip": _A_in["Dskip"],
        "B_x": _B_in["x"],
        "B_w1": _B_in["w1"],
        "B_w2": _B_in["w2"],
    }

def reference(A_u, A_A_re, A_A_im, A_B_re, A_B_im, A_C_re, A_C_im, A_log_dt, A_Dskip, B_x, B_w1, B_w2):
    def _A_ref(u, A_re, A_im, B_re, B_im, C_re, C_im, log_dt, Dskip):
        Bsz, L, D = u.shape
        dt = torch.exp(log_dt)[:, None]
        A = A_re + 1j * A_im
        Bc = B_re + 1j * B_im
        Cc = C_re + 1j * C_im
        logdA = dt * A
        dB = dt * Bc
        l = (lambda x, dt: x.to(dt))(torch.arange(L), A_re.dtype)
        P = torch.exp(logdA[:, :, None] * l[None, None, :])
        K = torch.einsum("dn,dnl,dn->dl", Cc, P, dB).real
        L2 = 2 * L
        Kp = _pad(K, ((0, 0), (0, L)))
        up = (lambda x, *d: x.permute(*d))(u, 0, 2, 1)
        up = _pad(up, ((0, 0), (0, 0), (0, L)))
        Kf = (lambda x, axes=(-2,-1): torch.fft.rfft2(x.float(), dim=axes))(Kp[:, None, :], axes=(-2, -1))
        Uf = (lambda x, axes=(-2,-1): torch.fft.rfft2(x.float(), dim=axes))(up[:, :, None, :], axes=(-2, -1))
        Yf = Uf * Kf[None, :, :, :]
        y = (lambda x, s, axes=(-2,-1): torch.fft.irfft2(x, s=s, dim=axes).to(torch.bfloat16))(Yf, (1, L2), axes=(-2, -1))[:, :, 0, :L]
        y = (lambda x, *d: x.permute(*d))(y, 0, 2, 1) + u * Dskip[None, None, :]
        return y

    def _B_ref(x, w1, w2):
        h = torch.einsum("bsd,df->bsf", x, w1)
        zero = torch.zeros_like(h)
        h = torch.maximum(h, zero)
        return torch.einsum("bsf,fd->bsd", h, w2)

    x = A_u
    h = x + _A_ref(_layernorm(x, axis=-1), A_A_re, A_A_im, A_B_re, A_B_im, A_C_re, A_C_im, A_log_dt, A_Dskip)
    h2 = h + _B_ref(_layernorm(h, axis=-1), B_w1, B_w2)
    return h2
```

```asm
; @launch kernel=k1_kernel grid=(256,1,1) block=(512,1,1) lds=154368
; @launch kernel=k3_kernel grid=(256,1,1) block=(512,1,1) lds=114688
; @launch kernel=k4_kernel grid=(256,1,1) block=(512,1,1) lds=163840
.amdgcn_target "amdgcn-amd-amdhsa--gfx950"
.text
.globl k1_kernel
.p2align 8
.type k1_kernel,@function
k1_kernel:

    s_cmp_ge_u32 s2, 256
    s_cbranch_scc1 K1_END
    s_load_dwordx16 s[16:31], s[0:1], 0
    s_load_dwordx2 s[32:33], s[0:1], 112
    s_load_dwordx4 s[36:39], s[0:1], 80
    s_load_dwordx2 s[34:35], s[0:1], 104
    s_load_dwordx2 s[60:61], s[0:1], 64
    v_lshrrev_b32 v1, 6, v0
    v_and_b32 v2, 63, v0
    v_readfirstlane_b32 s3, v1
    s_cmp_lt_u32 s2, 32
    s_cbranch_scc1 K1_LN
    s_sub_u32 s58, s2, 32
    s_lshr_b32 s4, s3, 2
    s_bfe_u32 s5, s3, 0x10001
    s_and_b32 s56, s3, 1
    s_lshl_b32 s6, s58, 1
    s_add_u32 s6, s6, s4
    s_lshl_b32 s7, s6, 9
    s_lshl_b32 s8, s5, 8
    s_add_u32 s7, s7, s8
    v_lshlrev_b32 v3, 2, v2
    v_add_u32 v3, s7, v3
    s_lshl_b32 s10, s58, 2
    v_mov_b32 v40, 0
    v_mov_b32 v41, 0
    v_mov_b32 v42, 0
    v_mov_b32 v43, 0
    v_lshlrev_b32 v44, 4, v0
    v_add_u32 v44, 139264, v44
    v_cmp_gt_u32 vcc, 150, v0
    s_and_saveexec_b64 s[12:13], vcc
    ds_write_b128 v44, v[40:43]
    ds_write_b128 v44, v[40:43] offset:7552
    s_mov_b64 exec, s[12:13]
    s_waitcnt lgkmcnt(0)
    global_load_dword v10, v3, s[18:19]
    global_load_dword v11, v3, s[20:21]
    global_load_dword v12, v3, s[22:23]
    global_load_dword v13, v3, s[24:25]
    global_load_dword v14, v3, s[26:27]
    global_load_dword v15, v3, s[28:29]
    s_load_dword s9, s[30:31], s10
    s_load_dword s59, s[60:61], s10
    s_lshl_b32 s40, s58, 3
    s_add_u32 s40, s40, s3
    s_min_u32 s40, s40, 1567
    s_cmp_ge_u32 s40, 784
    s_cselect_b32 s41, 784, 0
    s_sub_u32 s42, s40, s41
    s_mul_i32 s43, s42, 4682
    s_lshr_b32 s43, s43, 16
    s_mul_i32 s44, s43, 14
    s_sub_u32 s44, s42, s44
    s_mov_b32 s45, 3584
    s_mov_b32 s46, 64
    s_mov_b32 s47, 114688
    s_mov_b32 s48, 28672
    s_mov_b32 s49, 1024
    s_mov_b32 s50, 14336
    s_mov_b32 s51, 16777216
    s_mov_b32 s52, s36
    s_mov_b32 s53, s37
    s_cmp_lt_u32 s40, 784
    s_cbranch_scc1 K1_WSEL
    s_mov_b32 s45, 896
    s_mov_b32 s46, 28672
    s_mov_b32 s47, 64
    s_mov_b32 s48, 1024
    s_mov_b32 s49, 114688
    s_mov_b32 s50, 57344
    s_mov_b32 s51, 18874368
    s_mov_b32 s52, s38
    s_mov_b32 s53, s39
K1_WSEL:
    s_mul_i32 s54, s43, s46
    s_mul_i32 s55, s44, s47
    s_add_u32 s54, s54, s55
    s_mul_i32 s55, s43, s48
    s_mul_i32 s41, s44, s49
    s_add_u32 s55, s55, s41
    s_add_u32 s55, s55, s51
    v_and_b32 v5, 15, v2
    v_lshrrev_b32 v6, 4, v2
    v_lshrrev_b32 v237, 2, v5
    v_lshlrev_b32 v237, 3, v237
    v_and_b32 v236, 3, v5
    v_add_u32 v236, v236, v237
    v_mul_lo_u32 v236, v236, s45
    v_lshl_add_u32 v236, v6, 4, v236
    v_add_u32 v236, s54, v236
    s_lshl_b32 s41, s45, 2
    v_add_u32 v237, s41, v236
    s_mul_i32 s11, s3, 17408
    s_and_b32 s57, s3, 6
    s_mul_i32 s57, s57, 17408
    v_lshlrev_b32 v4, 3, v2
    v_add_u32 v4, s11, v4
    v_mul_u32_u24 v7, 544, v5
    v_lshl_add_u32 v7, v6, 4, v7
    v_add_u32 v9, s57, v7
    v_add_u32 v7, s11, v7
    s_waitcnt lgkmcnt(0)
    s_lshl_b32 s12, s9, 16
    s_and_b32 s13, s9, 0xffff0000
    s_cmp_eq_u32 s4, 0
    s_cselect_b32 s9, s12, s13
    s_mov_b32 s12, 0x3fb8aa3b
    s_mov_b32 s13, 0x32a57060
    s_mov_b32 s14, 0x3f317218
    s_mov_b32 s15, 0xffff0000
    v_mov_b32 v16, s9
    v_mul_f32 v17, s12, v16
    v_fma_f32 v18, v16, s12, -v17
    v_fma_f32 v18, v16, s13, v18
    v_exp_f32 v17, v17
    v_mul_f32 v18, s14, v18
    v_fma_f32 v17, v17, v18, v17
    v_cvt_pk_bf16_f32 v17, v17, v17
    v_and_b32 v16, s15, v17
    s_waitcnt vmcnt(0)
    global_load_dwordx4 v[240:243], v236, s[52:53]
    global_load_dwordx4 v[244:247], v237, s[52:53]
    v_mul_u32_u24 v236, 3584, v0
    s_lshl_b32 s41, s58, 2
    v_add_u32 v236, s41, v236
    v_mov_b32 v252, v236
    v_lshlrev_b32 v84, 16, v10
    v_lshlrev_b32 v85, 16, v11
    v_lshlrev_b32 v86, 16, v12
    v_lshlrev_b32 v87, 16, v13
    v_lshlrev_b32 v88, 16, v14
    v_lshlrev_b32 v89, 16, v15
    v_mul_f32 v84, v16, v84
    v_mul_f32 v85, v16, v85
    v_mul_f32 v86, v16, v86
    v_mul_f32 v87, v16, v87
    v_mul_f32 v20, s12, v84
    v_mul_f32 v21, 0.15915494, v85
    v_pk_mul_f32 v[72:73], v[88:89], v[86:87] op_sel:[0,0] op_sel_hi:[0,1]
    v_pk_fma_f32 v[24:25], v[88:89], v[86:87], v[72:73] op_sel:[1,1,0] op_sel_hi:[1,0,1] neg_lo:[1,0,0]
    v_mul_f32 v90, 0x43000000, v20
    v_mul_f32 v91, 0x43000000, v21
    v_exp_f32 v90, v90
    v_fract_f32 v91, v91
    v_cos_f32 v92, v91
    v_sin_f32 v93, v91
    v_mul_f32 v36, v90, v92
    v_mul_f32 v37, v90, v93
    v_and_b32 v84, s15, v10
    v_and_b32 v85, s15, v11
    v_and_b32 v86, s15, v12
    v_and_b32 v87, s15, v13
    v_and_b32 v88, s15, v14
    v_and_b32 v89, s15, v15
    v_mul_f32 v84, v16, v84
    v_mul_f32 v85, v16, v85
    v_mul_f32 v86, v16, v86
    v_mul_f32 v87, v16, v87
    v_mul_f32 v22, s12, v84
    v_mul_f32 v23, 0.15915494, v85
    v_pk_mul_f32 v[74:75], v[88:89], v[86:87] op_sel:[0,0] op_sel_hi:[0,1]
    v_pk_fma_f32 v[26:27], v[88:89], v[86:87], v[74:75] op_sel:[1,1,0] op_sel_hi:[1,0,1] neg_lo:[1,0,0]
    v_mul_f32 v90, 0x43000000, v22
    v_mul_f32 v91, 0x43000000, v23
    v_exp_f32 v90, v90
    v_fract_f32 v91, v91
    v_cos_f32 v92, v91
    v_sin_f32 v93, v91
    v_mul_f32 v38, v90, v92
    v_mul_f32 v39, v90, v93
    s_cmp_eq_u32 s56, 1
    s_cbranch_scc1 K1_RB
    v_mul_f32 v90, 0x41000000, v20
    v_mul_f32 v91, 0x41000000, v21
    v_exp_f32 v90, v90
    v_fract_f32 v91, v91
    v_cos_f32 v92, v91
    v_sin_f32 v93, v91
    v_mul_f32 v32, v90, v92
    v_mul_f32 v33, v90, v93
    v_mul_f32 v90, 0x41000000, v22
    v_mul_f32 v91, 0x41000000, v23
    v_exp_f32 v90, v90
    v_fract_f32 v91, v91
    v_cos_f32 v92, v91
    v_sin_f32 v93, v91
    v_mul_f32 v34, v90, v92
    v_mul_f32 v35, v90, v93
    v_mov_b32 v64, 1.0
    v_mov_b32 v65, 0
    v_mov_b32 v66, 1.0
    v_mov_b32 v67, 0
    v_cvt_pk_bf16_f32 v80, v64, v65
    v_cvt_pk_bf16_f32 v81, v66, v67
    ds_write_b64 v4, v[80:81] offset:0
    v_lshlrev_b32 v76, 16, v80
    v_and_b32 v77, s15, v80
    v_pk_add_f32 v[76:77], v[64:65], v[76:77] neg_lo:[0,1] neg_hi:[0,1]
    v_cvt_pk_bf16_f32 v82, v76, v77
    v_lshlrev_b32 v78, 16, v81
    v_and_b32 v79, s15, v81
    v_pk_add_f32 v[78:79], v[66:67], v[78:79] neg_lo:[0,1] neg_hi:[0,1]
    v_cvt_pk_bf16_f32 v83, v78, v79
    ds_write_b64 v4, v[82:83] offset:8704
    v_cvt_pk_bf16_f32 v80, v32, v33
    v_cvt_pk_bf16_f32 v81, v34, v35
    ds_write_b64 v4, v[80:81] offset:544
    v_lshlrev_b32 v76, 16, v80
    v_and_b32 v77, s15, v80
    v_pk_add_f32 v[76:77], v[32:33], v[76:77] neg_lo:[0,1] neg_hi:[0,1]
    v_cvt_pk_bf16_f32 v82, v76, v77
    v_lshlrev_b32 v78, 16, v81
    v_and_b32 v79, s15, v81
    v_pk_add_f32 v[78:79], v[34:35], v[78:79] neg_lo:[0,1] neg_hi:[0,1]
    v_cvt_pk_bf16_f32 v83, v78, v79
    ds_write_b64 v4, v[82:83] offset:9248
    v_pk_mul_f32 v[72:73], v[32:33], v[32:33] op_sel:[0,0] op_sel_hi:[0,1]
    v_pk_fma_f32 v[64:65], v[32:33], v[32:33], v[72:73] op_sel:[1,1,0] op_sel_hi:[1,0,1] neg_lo:[1,0,0]
    v_pk_mul_f32 v[74:75], v[34:35], v[34:35] op_sel:[0,0] op_sel_hi:[0,1]
    v_pk_fma_f32 v[66:67], v[34:35], v[34:35], v[74:75] op_sel:[1,1,0] op_sel_hi:[1,0,1] neg_lo:[1,0,0]
    global_load_dword v248, v252, s[16:17] offset:0
    v_cvt_pk_bf16_f32 v80, v64, v65
    v_cvt_pk_bf16_f32 v81, v66, v67
    ds_write_b64 v4, v[80:81] offset:1088
    v_lshlrev_b32 v76, 16, v80
    v_and_b32 v77, s15, v80
    v_pk_add_f32 v[76:77], v[64:65], v[76:77] neg_lo:[0,1] neg_hi:[0,1]
    v_cvt_pk_bf16_f32 v82, v76, v77
    v_lshlrev_b32 v78, 16, v81
    v_and_b32 v79, s15, v81
    v_pk_add_f32 v[78:79], v[66:67], v[78:79] neg_lo:[0,1] neg_hi:[0,1]
    v_cvt_pk_bf16_f32 v83, v78, v79
    ds_write_b64 v4, v[82:83] offset:9792
    v_pk_mul_f32 v[72:73], v[64:65], v[32:33] op_sel:[0,0] op_sel_hi:[0,1]
    v_pk_fma_f32 v[64:65], v[64:65], v[32:33], v[72:73] op_sel:[1,1,0] op_sel_hi:[1,0,1] neg_lo:[1,0,0]
    v_pk_mul_f32 v[74:75], v[66:67], v[34:35] op_sel:[0,0] op_sel_hi:[0,1]
    v_pk_fma_f32 v[66:67], v[66:67], v[34:35], v[74:75] op_sel:[1,1,0] op_sel_hi:[1,0,1] neg_lo:[1,0,0]
    v_cvt_pk_bf16_f32 v80, v64, v65
    v_cvt_pk_bf16_f32 v81, v66, v67
    ds_write_b64 v4, v[80:81] offset:1632
    v_lshlrev_b32 v76, 16, v80
    v_and_b32 v77, s15, v80
    v_pk_add_f32 v[76:77], v[64:65], v[76:77] neg_lo:[0,1] neg_hi:[0,1]
    v_cvt_pk_bf16_f32 v82, v76, v77
    v_lshlrev_b32 v78, 16, v81
    v_and_b32 v79, s15, v81
    v_pk_add_f32 v[78:79], v[66:67], v[78:79] neg_lo:[0,1] neg_hi:[0,1]
    v_cvt_pk_bf16_f32 v83, v78, v79
    ds_write_b64 v4, v[82:83] offset:10336
    v_pk_mul_f32 v[72:73], v[64:65], v[32:33] op_sel:[0,0] op_sel_hi:[0,1]
    v_pk_fma_f32 v[64:65], v[64:65], v[32:33], v[72:73] op_sel:[1,1,0] op_sel_hi:[1,0,1] neg_lo:[1,0,0]
    v_pk_mul_f32 v[74:75], v[66:67], v[34:35] op_sel:[0,0] op_sel_hi:[0,1]
    v_pk_fma_f32 v[66:67], v[66:67], v[34:35], v[74:75] op_sel:[1,1,0] op_sel_hi:[1,0,1] neg_lo:[1,0,0]
    v_cvt_pk_bf16_f32 v80, v64, v65
    v_cvt_pk_bf16_f32 v81, v66, v67
    ds_write_b64 v4, v[80:81] offset:2176
    v_lshlrev_b32 v76, 16, v80
    v_and_b32 v77, s15, v80
    v_pk_add_f32 v[76:77], v[64:65], v[76:77] neg_lo:[0,1] neg_hi:[0,1]
    v_cvt_pk_bf16_f32 v82, v76, v77
    v_lshlrev_b32 v78, 16, v81
    v_and_b32 v79, s15, v81
    v_pk_add_f32 v[78:79], v[66:67], v[78:79] neg_lo:[0,1] neg_hi:[0,1]
    v_cvt_pk_bf16_f32 v83, v78, v79
    ds_write_b64 v4, v[82:83] offset:10880
    v_pk_mul_f32 v[72:73], v[64:65], v[32:33] op_sel:[0,0] op_sel_hi:[0,1]
    v_pk_fma_f32 v[64:65], v[64:65], v[32:33], v[72:73] op_sel:[1,1,0] op_sel_hi:[1,0,1] neg_lo:[1,0,0]
    v_pk_mul_f32 v[74:75], v[66:67], v[34:35] op_sel:[0,0] op_sel_hi:[0,1]
    v_pk_fma_f32 v[66:67], v[66:67], v[34:35], v[74:75] op_sel:[1,1,0] op_sel_hi:[1,0,1] neg_lo:[1,0,0]
    v_cvt_pk_bf16_f32 v80, v64, v65
    v_cvt_pk_bf16_f32 v81, v66, v67
    ds_write_b64 v4, v[80:81] offset:2720
    v_lshlrev_b32 v76, 16, v80
    v_and_b32 v77, s15, v80
    v_pk_add_f32 v[76:77], v[64:65], v[76:77] neg_lo:[0,1] neg_hi:[0,1]
    v_cvt_pk_bf16_f32 v82, v76, v77
    v_lshlrev_b32 v78, 16, v81
    v_and_b32 v79, s15, v81
    v_pk_add_f32 v[78:79], v[66:67], v[78:79] neg_lo:[0,1] neg_hi:[0,1]
    v_cvt_pk_bf16_f32 v83, v78, v79
    ds_write_b64 v4, v[82:83] offset:11424
    v_pk_mul_f32 v[72:73], v[64:65], v[32:33] op_sel:[0,0] op_sel_hi:[0,1]
    v_pk_fma_f32 v[64:65], v[64:65], v[32:33], v[72:73] op_sel:[1,1,0] op_sel_hi:[1,0,1] neg_lo:[1,0,0]
    v_pk_mul_f32 v[74:75], v[66:67], v[34:35] op_sel:[0,0] op_sel_hi:[0,1]
    v_pk_fma_f32 v[66:67], v[66:67], v[34:35], v[74:75] op_sel:[1,1,0] op_sel_hi:[1,0,1] neg_lo:[1,0,0]
    v_cvt_pk_bf16_f32 v80, v64, v65
    v_cvt_pk_bf16_f32 v81, v66, v67
    ds_write_b64 v4, v[80:81] offset:3264
    v_lshlrev_b32 v76, 16, v80
    v_and_b32 v77, s15, v80
    v_pk_add_f32 v[76:77], v[64:65], v[76:77] neg_lo:[0,1] neg_hi:[0,1]
    v_cvt_pk_bf16_f32 v82, v76, v77
    v_lshlrev_b32 v78, 16, v81
    v_and_b32 v79, s15, v81
    v_pk_add_f32 v[78:79], v[66:67], v[78:79] neg_lo:[0,1] neg_hi:[0,1]
    v_cvt_pk_bf16_f32 v83, v78, v79
    ds_write_b64 v4, v[82:83] offset:11968
    v_pk_mul_f32 v[72:73], v[64:65], v[32:33] op_sel:[0,0] op_sel_hi:[0,1]
    v_pk_fma_f32 v[64:65], v[64:65], v[32:33], v[72:73] op_sel:[1,1,0] op_sel_hi:[1,0,1] neg_lo:[1,0,0]
    v_pk_mul_f32 v[74:75], v[66:67], v[34:35] op_sel:[0,0] op_sel_hi:[0,1]
    v_pk_fma_f32 v[66:67], v[66:67], v[34:35], v[74:75] op_sel:[1,1,0] op_sel_hi:[1,0,1] neg_lo:[1,0,0]
    global_load_dword v249, v252, s[16:17] offset:896
    v_cvt_pk_bf16_f32 v80, v64, v65
    v_cvt_pk_bf16_f32 v81, v66, v67
    ds_write_b64 v4, v[80:81] offset:3808
    v_lshlrev_b32 v76, 16, v80
    v_and_b32 v77, s15, v80
    v_pk_add_f32 v[76:77], v[64:65], v[76:77] neg_lo:[0,1] neg_hi:[0,1]
    v_cvt_pk_bf16_f32 v82, v76, v77
    v_lshlrev_b32 v78, 16, v81
    v_and_b32 v79, s15, v81
    v_pk_add_f32 v[78:79], v[66:67], v[78:79] neg_lo:[0,1] neg_hi:[0,1]
    v_cvt_pk_bf16_f32 v83, v78, v79
    ds_write_b64 v4, v[82:83] offset:12512
    v_pk_mul_f32 v[72:73], v[64:65], v[32:33] op_sel:[0,0] op_sel_hi:[0,1]
    v_pk_fma_f32 v[64:65], v[64:65], v[32:33], v[72:73] op_sel:[1,1,0] op_sel_hi:[1,0,1] neg_lo:[1,0,0]
    v_pk_mul_f32 v[74:75], v[66:67], v[34:35] op_sel:[0,0] op_sel_hi:[0,1]
    v_pk_fma_f32 v[66:67], v[66:67], v[34:35], v[74:75] op_sel:[1,1,0] op_sel_hi:[1,0,1] neg_lo:[1,0,0]
    v_cvt_pk_bf16_f32 v80, v64, v65
    v_cvt_pk_bf16_f32 v81, v66, v67
    ds_write_b64 v4, v[80:81] offset:4352
    v_lshlrev_b32 v76, 16, v80
    v_and_b32 v77, s15, v80
    v_pk_add_f32 v[76:77], v[64:65], v[76:77] neg_lo:[0,1] neg_hi:[0,1]
    v_cvt_pk_bf16_f32 v82, v76, v77
    v_lshlrev_b32 v78, 16, v81
    v_and_b32 v79, s15, v81
    v_pk_add_f32 v[78:79], v[66:67], v[78:79] neg_lo:[0,1] neg_hi:[0,1]
    v_cvt_pk_bf16_f32 v83, v78, v79
    ds_write_b64 v4, v[82:83] offset:13056
    v_pk_mul_f32 v[72:73], v[64:65], v[32:33] op_sel:[0,0] op_sel_hi:[0,1]
    v_pk_fma_f32 v[64:65], v[64:65], v[32:33], v[72:73] op_sel:[1,1,0] op_sel_hi:[1,0,1] neg_lo:[1,0,0]
    v_pk_mul_f32 v[74:75], v[66:67], v[34:35] op_sel:[0,0] op_sel_hi:[0,1]
    v_pk_fma_f32 v[66:67], v[66:67], v[34:35], v[74:75] op_sel:[1,1,0] op_sel_hi:[1,0,1] neg_lo:[1,0,0]
    v_cvt_pk_bf16_f32 v80, v64, v65
    v_cvt_pk_bf16_f32 v81, v66, v67
    ds_write_b64 v4, v[80:81] offset:4896
    v_lshlrev_b32 v76, 16, v80
    v_and_b32 v77, s15, v80
    v_pk_add_f32 v[76:77], v[64:65], v[76:77] neg_lo:[0,1] neg_hi:[0,1]
    v_cvt_pk_bf16_f32 v82, v76, v77
    v_lshlrev_b32 v78, 16, v81
    v_and_b32 v79, s15, v81
    v_pk_add_f32 v[78:79], v[66:67], v[78:79] neg_lo:[0,1] neg_hi:[0,1]
    v_cvt_pk_bf16_f32 v83, v78, v79
    ds_write_b64 v4, v[82:83] offset:13600
    v_pk_mul_f32 v[72:73], v[64:65], v[32:33] op_sel:[0,0] op_sel_hi:[0,1]
    v_pk_fma_f32 v[64:65], v[64:65], v[32:33], v[72:73] op_sel:[1,1,0] op_sel_hi:[1,0,1] neg_lo:[1,0,0]
    v_pk_mul_f32 v[74:75], v[66:67], v[34:35] op_sel:[0,0] op_sel_hi:[0,1]
    v_pk_fma_f32 v[66:67], v[66:67], v[34:35], v[74:75] op_sel:[1,1,0] op_sel_hi:[1,0,1] neg_lo:[1,0,0]
    v_cvt_pk_bf16_f32 v80, v64, v65
    v_cvt_pk_bf16_f32 v81, v66, v67
    ds_write_b64 v4, v[80:81] offset:5440
    v_lshlrev_b32 v76, 16, v80
    v_and_b32 v77, s15, v80
    v_pk_add_f32 v[76:77], v[64:65], v[76:77] neg_lo:[0,1] neg_hi:[0,1]
    v_cvt_pk_bf16_f32 v82, v76, v77
    v_lshlrev_b32 v78, 16, v81
    v_and_b32 v79, s15, v81
    v_pk_add_f32 v[78:79], v[66:67], v[78:79] neg_lo:[0,1] neg_hi:[0,1]
    v_cvt_pk_bf16_f32 v83, v78, v79
    ds_write_b64 v4, v[82:83] offset:14144
    v_pk_mul_f32 v[72:73], v[64:65], v[32:33] op_sel:[0,0] op_sel_hi:[0,1]
    v_pk_fma_f32 v[64:65], v[64:65], v[32:33], v[72:73] op_sel:[1,1,0] op_sel_hi:[1,0,1] neg_lo:[1,0,0]
    v_pk_mul_f32 v[74:75], v[66:67], v[34:35] op_sel:[0,0] op_sel_hi:[0,1]
    v_pk_fma_f32 v[66:67], v[66:67], v[34:35], v[74:75] op_sel:[1,1,0] op_sel_hi:[1,0,1] neg_lo:[1,0,0]
    v_cvt_pk_bf16_f32 v80, v64, v65
    v_cvt_pk_bf16_f32 v81, v66, v67
    ds_write_b64 v4, v[80:81] offset:5984
    v_lshlrev_b32 v76, 16, v80
    v_and_b32 v77, s15, v80
    v_pk_add_f32 v[76:77], v[64:65], v[76:77] neg_lo:[0,1] neg_hi:[0,1]
    v_cvt_pk_bf16_f32 v82, v76, v77
    v_lshlrev_b32 v78, 16, v81
    v_and_b32 v79, s15, v81
    v_pk_add_f32 v[78:79], v[66:67], v[78:79] neg_lo:[0,1] neg_hi:[0,1]
    v_cvt_pk_bf16_f32 v83, v78, v79
    ds_write_b64 v4, v[82:83] offset:14688
    v_pk_mul_f32 v[72:73], v[64:65], v[32:33] op_sel:[0,0] op_sel_hi:[0,1]
    v_pk_fma_f32 v[64:65], v[64:65], v[32:33], v[72:73] op_sel:[1,1,0] op_sel_hi:[1,0,1] neg_lo:[1,0,0]
    v_pk_mul_f32 v[74:75], v[66:67], v[34:35] op_sel:[0,0] op_sel_hi:[0,1]
    v_pk_fma_f32 v[66:67], v[66:67], v[34:35], v[74:75] op_sel:[1,1,0] op_sel_hi:[1,0,1] neg_lo:[1,0,0]
    global_load_dword v250, v252, s[16:17] offset:1792
    v_cvt_pk_bf16_f32 v80, v64, v65
    v_cvt_pk_bf16_f32 v81, v66, v67
    ds_write_b64 v4, v[80:81] offset:6528
    v_lshlrev_b32 v76, 16, v80
    v_and_b32 v77, s15, v80
    v_pk_add_f32 v[76:77], v[64:65], v[76:77] neg_lo:[0,1] neg_hi:[0,1]
    v_cvt_pk_bf16_f32 v82, v76, v77
    v_lshlrev_b32 v78, 16, v81
    v_and_b32 v79, s15, v81
    v_pk_add_f32 v[78:79], v[66:67], v[78:79] neg_lo:[0,1] neg_hi:[0,1]
    v_cvt_pk_bf16_f32 v83, v78, v79
    ds_write_b64 v4, v[82:83] offset:15232
    v_pk_mul_f32 v[72:73], v[64:65], v[32:33] op_sel:[0,0] op_sel_hi:[0,1]
    v_pk_fma_f32 v[64:65], v[64:65], v[32:33], v[72:73] op_sel:[1,1,0] op_sel_hi:[1,0,1] neg_lo:[1,0,0]
    v_pk_mul_f32 v[74:75], v[66:67], v[34:35] op_sel:[0,0] op_sel_hi:[0,1]
    v_pk_fma_f32 v[66:67], v[66:67], v[34:35], v[74:75] op_sel:[1,1,0] op_sel_hi:[1,0,1] neg_lo:[1,0,0]
    v_cvt_pk_bf16_f32 v80, v64, v65
    v_cvt_pk_bf16_f32 v81, v66, v67
    ds_write_b64 v4, v[80:81] offset:7072
    v_lshlrev_b32 v76, 16, v80
    v_and_b32 v77, s15, v80
    v_pk_add_f32 v[76:77], v[64:65], v[76:77] neg_lo:[0,1] neg_hi:[0,1]
    v_cvt_pk_bf16_f32 v82, v76, v77
    v_lshlrev_b32 v78, 16, v81
    v_and_b32 v79, s15, v81
    v_pk_add_f32 v[78:79], v[66:67], v[78:79] neg_lo:[0,1] neg_hi:[0,1]
    v_cvt_pk_bf16_f32 v83, v78, v79
    ds_write_b64 v4, v[82:83] offset:15776
    v_pk_mul_f32 v[72:73], v[64:65], v[32:33] op_sel:[0,0] op_sel_hi:[0,1]
    v_pk_fma_f32 v[64:65], v[64:65], v[32:33], v[72:73] op_sel:[1,1,0] op_sel_hi:[1,0,1] neg_lo:[1,0,0]
    v_pk_mul_f32 v[74:75], v[66:67], v[34:35] op_sel:[0,0] op_sel_hi:[0,1]
    v_pk_fma_f32 v[66:67], v[66:67], v[34:35], v[74:75] op_sel:[1,1,0] op_sel_hi:[1,0,1] neg_lo:[1,0,0]
    v_cvt_pk_bf16_f32 v80, v64, v65
    v_cvt_pk_bf16_f32 v81, v66, v67
    ds_write_b64 v4, v[80:81] offset:7616
    v_lshlrev_b32 v76, 16, v80
    v_and_b32 v77, s15, v80
    v_pk_add_f32 v[76:77], v[64:65], v[76:77] neg_lo:[0,1] neg_hi:[0,1]
    v_cvt_pk_bf16_f32 v82, v76, v77
    v_lshlrev_b32 v78, 16, v81
    v_and_b32 v79, s15, v81
    v_pk_add_f32 v[78:79], v[66:67], v[78:79] neg_lo:[0,1] neg_hi:[0,1]
    v_cvt_pk_bf16_f32 v83, v78, v79
    ds_write_b64 v4, v[82:83] offset:16320
    v_pk_mul_f32 v[72:73], v[64:65], v[32:33] op_sel:[0,0] op_sel_hi:[0,1]
    v_pk_fma_f32 v[64:65], v[64:65], v[32:33], v[72:73] op_sel:[1,1,0] op_sel_hi:[1,0,1] neg_lo:[1,0,0]
    v_pk_mul_f32 v[74:75], v[66:67], v[34:35] op_sel:[0,0] op_sel_hi:[0,1]
    v_pk_fma_f32 v[66:67], v[66:67], v[34:35], v[74:75] op_sel:[1,1,0] op_sel_hi:[1,0,1] neg_lo:[1,0,0]
    v_cvt_pk_bf16_f32 v80, v64, v65
    v_cvt_pk_bf16_f32 v81, v66, v67
    ds_write_b64 v4, v[80:81] offset:8160
    v_lshlrev_b32 v76, 16, v80
    v_and_b32 v77, s15, v80
    v_pk_add_f32 v[76:77], v[64:65], v[76:77] neg_lo:[0,1] neg_hi:[0,1]
    v_cvt_pk_bf16_f32 v82, v76, v77
    v_lshlrev_b32 v78, 16, v81
    v_and_b32 v79, s15, v81
    v_pk_add_f32 v[78:79], v[66:67], v[78:79] neg_lo:[0,1] neg_hi:[0,1]
    v_cvt_pk_bf16_f32 v83, v78, v79
    ds_write_b64 v4, v[82:83] offset:16864
    v_exp_f32 v90, v20
    v_fract_f32 v91, v21
    v_cos_f32 v92, v91
    v_sin_f32 v93, v91
    v_mul_f32 v28, v90, v92
    v_mul_f32 v29, v90, v93
    v_exp_f32 v90, v22
    v_fract_f32 v91, v23
    v_cos_f32 v92, v91
    v_sin_f32 v93, v91
    v_mul_f32 v30, v90, v92
    v_mul_f32 v31, v90, v93
    v_pk_mul_f32 v[72:73], v[28:29], v[28:29] op_sel:[0,0] op_sel_hi:[0,1]
    v_pk_fma_f32 v[40:41], v[28:29], v[28:29], v[72:73] op_sel:[1,1,0] op_sel_hi:[1,0,1] neg_lo:[1,0,0]
    v_pk_mul_f32 v[74:75], v[30:31], v[30:31] op_sel:[0,0] op_sel_hi:[0,1]
    v_pk_fma_f32 v[42:43], v[30:31], v[30:31], v[74:75] op_sel:[1,1,0] op_sel_hi:[1,0,1] neg_lo:[1,0,0]
    v_pk_mul_f32 v[72:73], v[40:41], v[28:29] op_sel:[0,0] op_sel_hi:[0,1]
    v_pk_fma_f32 v[44:45], v[40:41], v[28:29], v[72:73] op_sel:[1,1,0] op_sel_hi:[1,0,1] neg_lo:[1,0,0]
    v_pk_mul_f32 v[74:75], v[42:43], v[30:31] op_sel:[0,0] op_sel_hi:[0,1]
    v_pk_fma_f32 v[46:47], v[42:43], v[30:31], v[74:75] op_sel:[1,1,0] op_sel_hi:[1,0,1] neg_lo:[1,0,0]
    v_pk_mul_f32 v[72:73], v[44:45], v[28:29] op_sel:[0,0] op_sel_hi:[0,1]
    v_pk_fma_f32 v[48:49], v[44:45], v[28:29], v[72:73] op_sel:[1,1,0] op_sel_hi:[1,0,1] neg_lo:[1,0,0]
    v_pk_mul_f32 v[74:75], v[46:47], v[30:31] op_sel:[0,0] op_sel_hi:[0,1]
    v_pk_fma_f32 v[50:51], v[46:47], v[30:31], v[74:75] op_sel:[1,1,0] op_sel_hi:[1,0,1] neg_lo:[1,0,0]
    v_pk_mul_f32 v[72:73], v[48:49], v[28:29] op_sel:[0,0] op_sel_hi:[0,1]
    v_pk_fma_f32 v[52:53], v[48:49], v[28:29], v[72:73] op_sel:[1,1,0] op_sel_hi:[1,0,1] neg_lo:[1,0,0]
    v_pk_mul_f32 v[74:75], v[50:51], v[30:31] op_sel:[0,0] op_sel_hi:[0,1]
    v_pk_fma_f32 v[54:55], v[50:51], v[30:31], v[74:75] op_sel:[1,1,0] op_sel_hi:[1,0,1] neg_lo:[1,0,0]
    v_pk_mul_f32 v[72:73], v[52:53], v[28:29] op_sel:[0,0] op_sel_hi:[0,1]
    v_pk_fma_f32 v[56:57], v[52:53], v[28:29], v[72:73] op_sel:[1,1,0] op_sel_hi:[1,0,1] neg_lo:[1,0,0]
    v_pk_mul_f32 v[74:75], v[54:55], v[30:31] op_sel:[0,0] op_sel_hi:[0,1]
    v_pk_fma_f32 v[58:59], v[54:55], v[30:31], v[74:75] op_sel:[1,1,0] op_sel_hi:[1,0,1] neg_lo:[1,0,0]
    v_pk_mul_f32 v[72:73], v[56:57], v[28:29] op_sel:[0,0] op_sel_hi:[0,1]
    v_pk_fma_f32 v[60:61], v[56:57], v[28:29], v[72:73] op_sel:[1,1,0] op_sel_hi:[1,0,1] neg_lo:[1,0,0]
    v_pk_mul_f32 v[74:75], v[58:59], v[30:31] op_sel:[0,0] op_sel_hi:[0,1]
    v_pk_fma_f32 v[62:63], v[58:59], v[30:31], v[74:75] op_sel:[1,1,0] op_sel_hi:[1,0,1] neg_lo:[1,0,0]
    s_waitcnt lgkmcnt(0)
    s_barrier
    ds_read_b128 v[96:99], v9 offset:0
    ds_read_b128 v[100:103], v9 offset:8704
    ds_read_b128 v[104:107], v9 offset:64
    ds_read_b128 v[108:111], v9 offset:8768
    ds_read_b128 v[112:115], v9 offset:128
    ds_read_b128 v[116:119], v9 offset:8832
    ds_read_b128 v[120:123], v9 offset:192
    ds_read_b128 v[124:127], v9 offset:8896
    ds_read_b128 v[128:131], v9 offset:256
    ds_read_b128 v[132:135], v9 offset:8960
    ds_read_b128 v[136:139], v9 offset:320
    ds_read_b128 v[140:143], v9 offset:9024
    ds_read_b128 v[144:147], v9 offset:384
    ds_read_b128 v[148:151], v9 offset:9088
    ds_read_b128 v[152:155], v9 offset:448
    ds_read_b128 v[156:159], v9 offset:9152
    s_waitcnt lgkmcnt(0)
    s_barrier
    v_cvt_pk_bf16_f32 v80, v24, -v25
    v_cvt_pk_bf16_f32 v81, v26, -v27
    ds_write_b64 v4, v[80:81] offset:0
    v_lshlrev_b32 v76, 16, v80
    v_and_b32 v77, s15, v80
    v_pk_add_f32 v[76:77], v[24:25], v[76:77] neg_lo:[0,1] neg_hi:[1,1]
    v_cvt_pk_bf16_f32 v82, v76, v77
    v_lshlrev_b32 v78, 16, v81
    v_and_b32 v79, s15, v81
    v_pk_add_f32 v[78:79], v[26:27], v[78:79] neg_lo:[0,1] neg_hi:[1,1]
    v_cvt_pk_bf16_f32 v83, v78, v79
    ds_write_b64 v4, v[82:83] offset:8704
    v_pk_mul_f32 v[72:73], v[24:25], v[28:29] op_sel:[0,0] op_sel_hi:[0,1]
    v_pk_fma_f32 v[68:69], v[24:25], v[28:29], v[72:73] op_sel:[1,1,0] op_sel_hi:[1,0,1] neg_lo:[1,0,0]
    v_pk_mul_f32 v[74:75], v[26:27], v[30:31] op_sel:[0,0] op_sel_hi:[0,1]
    v_pk_fma_f32 v[70:71], v[26:27], v[30:31], v[74:75] op_sel:[1,1,0] op_sel_hi:[1,0,1] neg_lo:[1,0,0]
    global_load_dword v251, v252, s[16:17] offset:2688
    v_cvt_pk_bf16_f32 v80, v68, -v69
    v_cvt_pk_bf16_f32 v81, v70, -v71
    ds_write_b64 v4, v[80:81] offset:544
    v_lshlrev_b32 v76, 16, v80
    v_and_b32 v77, s15, v80
    v_pk_add_f32 v[76:77], v[68:69], v[76:77] neg_lo:[0,1] neg_hi:[1,1]
    v_cvt_pk_bf16_f32 v82, v76, v77
    v_lshlrev_b32 v78, 16, v81
    v_and_b32 v79, s15, v81
    v_pk_add_f32 v[78:79], v[70:71], v[78:79] neg_lo:[0,1] neg_hi:[1,1]
    v_cvt_pk_bf16_f32 v83, v78, v79
    ds_write_b64 v4, v[82:83] offset:9248
    v_pk_mul_f32 v[72:73], v[24:25], v[40:41] op_sel:[0,0] op_sel_hi:[0,1]
    v_pk_fma_f32 v[68:69], v[24:25], v[40:41], v[72:73] op_sel:[1,1,0] op_sel_hi:[1,0,1] neg_lo:[1,0,0]
    v_pk_mul_f32 v[74:75], v[26:27], v[42:43] op_sel:[0,0] op_sel_hi:[0,1]
    v_pk_fma_f32 v[70:71], v[26:27], v[42:43], v[74:75] op_sel:[1,1,0] op_sel_hi:[1,0,1] neg_lo:[1,0,0]
    v_cvt_pk_bf16_f32 v80, v68, -v69
    v_cvt_pk_bf16_f32 v81, v70, -v71
    ds_write_b64 v4, v[80:81] offset:1088
    v_lshlrev_b32 v76, 16, v80
    v_and_b32 v77, s15, v80
    v_pk_add_f32 v[76:77], v[68:69], v[76:77] neg_lo:[0,1] neg_hi:[1,1]
    v_cvt_pk_bf16_f32 v82, v76, v77
    v_lshlrev_b32 v78, 16, v81
    v_and_b32 v79, s15, v81
    v_pk_add_f32 v[78:79], v[70:71], v[78:79] neg_lo:[0,1] neg_hi:[1,1]
    v_cvt_pk_bf16_f32 v83, v78, v79
    ds_write_b64 v4, v[82:83] offset:9792
    v_pk_mul_f32 v[72:73], v[24:25], v[44:45] op_sel:[0,0] op_sel_hi:[0,1]
    v_pk_fma_f32 v[68:69], v[24:25], v[44:45], v[72:73] op_sel:[1,1,0] op_sel_hi:[1,0,1] neg_lo:[1,0,0]
    v_pk_mul_f32 v[74:75], v[26:27], v[46:47] op_sel:[0,0] op_sel_hi:[0,1]
    v_pk_fma_f32 v[70:71], v[26:27], v[46:47], v[74:75] op_sel:[1,1,0] op_sel_hi:[1,0,1] neg_lo:[1,0,0]
    v_cvt_pk_bf16_f32 v80, v68, -v69
    v_cvt_pk_bf16_f32 v81, v70, -v71
    ds_write_b64 v4, v[80:81] offset:1632
    v_lshlrev_b32 v76, 16, v80
    v_and_b32 v77, s15, v80
    v_pk_add_f32 v[76:77], v[68:69], v[76:77] neg_lo:[0,1] neg_hi:[1,1]
    v_cvt_pk_bf16_f32 v82, v76, v77
    v_lshlrev_b32 v78, 16, v81
    v_and_b32 v79, s15, v81
    v_pk_add_f32 v[78:79], v[70:71], v[78:79] neg_lo:[0,1] neg_hi:[1,1]
    v_cvt_pk_bf16_f32 v83, v78, v79
    ds_write_b64 v4, v[82:83] offset:10336
    v_pk_mul_f32 v[72:73], v[24:25], v[48:49] op_sel:[0,0] op_sel_hi:[0,1]
    v_pk_fma_f32 v[68:69], v[24:25], v[48:49], v[72:73] op_sel:[1,1,0] op_sel_hi:[1,0,1] neg_lo:[1,0,0]
    v_pk_mul_f32 v[74:75], v[26:27], v[50:51] op_sel:[0,0] op_sel_hi:[0,1]
    v_pk_fma_f32 v[70:71], v[26:27], v[50:51], v[74:75] op_sel:[1,1,0] op_sel_hi:[1,0,1] neg_lo:[1,0,0]
    v_cvt_pk_bf16_f32 v80, v68, -v69
    v_cvt_pk_bf16_f32 v81, v70, -v71
    ds_write_b64 v4, v[80:81] offset:2176
    v_lshlrev_b32 v76, 16, v80
    v_and_b32 v77, s15, v80
    v_pk_add_f32 v[76:77], v[68:69], v[76:77] neg_lo:[0,1] neg_hi:[1,1]
    v_cvt_pk_bf16_f32 v82, v76, v77
    v_lshlrev_b32 v78, 16, v81
    v_and_b32 v79, s15, v81
    v_pk_add_f32 v[78:79], v[70:71], v[78:79] neg_lo:[0,1] neg_hi:[1,1]
    v_cvt_pk_bf16_f32 v83, v78, v79
    ds_write_b64 v4, v[82:83] offset:10880
    v_pk_mul_f32 v[72:73], v[24:25], v[52:53] op_sel:[0,0] op_sel_hi:[0,1]
    v_pk_fma_f32 v[68:69], v[24:25], v[52:53], v[72:73] op_sel:[1,1,0] op_sel_hi:[1,0,1] neg_lo:[1,0,0]
    v_pk_mul_f32 v[74:75], v[26:27], v[54:55] op_sel:[0,0] op_sel_hi:[0,1]
    v_pk_fma_f32 v[70:71], v[26:27], v[54:55], v[74:75] op_sel:[1,1,0] op_sel_hi:[1,0,1] neg_lo:[1,0,0]
    v_cvt_pk_bf16_f32 v80, v68, -v69
    v_cvt_pk_bf16_f32 v81, v70, -v71
    ds_write_b64 v4, v[80:81] offset:2720
    v_lshlrev_b32 v76, 16, v80
    v_and_b32 v77, s15, v80
    v_pk_add_f32 v[76:77], v[68:69], v[76:77] neg_lo:[0,1] neg_hi:[1,1]
    v_cvt_pk_bf16_f32 v82, v76, v77
    v_lshlrev_b32 v78, 16, v81
    v_and_b32 v79, s15, v81
    v_pk_add_f32 v[78:79], v[70:71], v[78:79] neg_lo:[0,1] neg_hi:[1,1]
    v_cvt_pk_bf16_f32 v83, v78, v79
    ds_write_b64 v4, v[82:83] offset:11424
    v_pk_mul_f32 v[72:73], v[24:25], v[56:57] op_sel:[0,0] op_sel_hi:[0,1]
    v_pk_fma_f32 v[68:69], v[24:25], v[56:57], v[72:73] op_sel:[1,1,0] op_sel_hi:[1,0,1] neg_lo:[1,0,0]
    v_pk_mul_f32 v[74:75], v[26:27], v[58:59] op_sel:[0,0] op_sel_hi:[0,1]
    v_pk_fma_f32 v[70:71], v[26:27], v[58:59], v[74:75] op_sel:[1,1,0] op_sel_hi:[1,0,1] neg_lo:[1,0,0]
    v_cvt_pk_bf16_f32 v80, v68, -v69
    v_cvt_pk_bf16_f32 v81, v70, -v71
    ds_write_b64 v4, v[80:81] offset:3264
    v_lshlrev_b32 v76, 16, v80
    v_and_b32 v77, s15, v80
    v_pk_add_f32 v[76:77], v[68:69], v[76:77] neg_lo:[0,1] neg_hi:[1,1]
    v_cvt_pk_bf16_f32 v82, v76, v77
    v_lshlrev_b32 v78, 16, v81
    v_and_b32 v79, s15, v81
    v_pk_add_f32 v[78:79], v[70:71], v[78:79] neg_lo:[0,1] neg_hi:[1,1]
    v_cvt_pk_bf16_f32 v83, v78, v79
    ds_write_b64 v4, v[82:83] offset:11968
    v_pk_mul_f32 v[72:73], v[24:25], v[60:61] op_sel:[0,0] op_sel_hi:[0,1]
    v_pk_fma_f32 v[68:69], v[24:25], v[60:61], v[72:73] op_sel:[1,1,0] op_sel_hi:[1,0,1] neg_lo:[1,0,0]
    v_pk_mul_f32 v[74:75], v[26:27], v[62:63] op_sel:[0,0] op_sel_hi:[0,1]
    v_pk_fma_f32 v[70:71], v[26:27], v[62:63], v[74:75] op_sel:[1,1,0] op_sel_hi:[1,0,1] neg_lo:[1,0,0]
    v_cvt_pk_bf16_f32 v80, v68, -v69
    v_cvt_pk_bf16_f32 v81, v70, -v71
    ds_write_b64 v4, v[80:81] offset:3808
    v_lshlrev_b32 v76, 16, v80
    v_and_b32 v77, s15, v80
    v_pk_add_f32 v[76:77], v[68:69], v[76:77] neg_lo:[0,1] neg_hi:[1,1]
    v_cvt_pk_bf16_f32 v82, v76, v77
    v_lshlrev_b32 v78, 16, v81
    v_and_b32 v79, s15, v81
    v_pk_add_f32 v[78:79], v[70:71], v[78:79] neg_lo:[0,1] neg_hi:[1,1]
    v_cvt_pk_bf16_f32 v83, v78, v79
    ds_write_b64 v4, v[82:83] offset:12512
    v_pk_mul_f32 v[72:73], v[24:25], v[36:37] op_sel:[0,0] op_sel_hi:[0,1]
    v_pk_fma_f32 v[64:65], v[24:25], v[36:37], v[72:73] op_sel:[1,1,0] op_sel_hi:[1,0,1] neg_lo:[1,0,0]
    v_pk_mul_f32 v[74:75], v[26:27], v[38:39] op_sel:[0,0] op_sel_hi:[0,1]
    v_pk_fma_f32 v[66:67], v[26:27], v[38:39], v[74:75] op_sel:[1,1,0] op_sel_hi:[1,0,1] neg_lo:[1,0,0]
    v_cvt_pk_bf16_f32 v80, v64, -v65
    v_cvt_pk_bf16_f32 v81, v66, -v67
    ds_write_b64 v4, v[80:81] offset:4352
    v_lshlrev_b32 v76, 16, v80
    v_and_b32 v77, s15, v80
    v_pk_add_f32 v[76:77], v[64:65], v[76:77] neg_lo:[0,1] neg_hi:[1,1]
    v_cvt_pk_bf16_f32 v82, v76, v77
    v_lshlrev_b32 v78, 16, v81
    v_and_b32 v79, s15, v81
    v_pk_add_f32 v[78:79], v[66:67], v[78:79] neg_lo:[0,1] neg_hi:[1,1]
    v_cvt_pk_bf16_f32 v83, v78, v79
    ds_write_b64 v4, v[82:83] offset:13056
    v_pk_mul_f32 v[72:73], v[64:65], v[28:29] op_sel:[0,0] op_sel_hi:[0,1]
    v_pk_fma_f32 v[68:69], v[64:65], v[28:29], v[72:73] op_sel:[1,1,0] op_sel_hi:[1,0,1] neg_lo:[1,0,0]
    v_pk_mul_f32 v[74:75], v[66:67], v[30:31] op_sel:[0,0] op_sel_hi:[0,1]
    v_pk_fma_f32 v[70:71], v[66:67], v[30:31], v[74:75] op_sel:[1,1,0] op_sel_hi:[1,0,1] neg_lo:[1,0,0]
    v_cvt_pk_bf16_f32 v80, v68, -v69
    v_cvt_pk_bf16_f32 v81, v70, -v71
    ds_write_b64 v4, v[80:81] offset:4896
    v_lshlrev_b32 v76, 16, v80
    v_and_b32 v77, s15, v80
    v_pk_add_f32 v[76:77], v[68:69], v[76:77] neg_lo:[0,1] neg_hi:[1,1]
    v_cvt_pk_bf16_f32 v82, v76, v77
    v_lshlrev_b32 v78, 16, v81
    v_and_b32 v79, s15, v81
    v_pk_add_f32 v[78:79], v[70:71], v[78:79] neg_lo:[0,1] neg_hi:[1,1]
    v_cvt_pk_bf16_f32 v83, v78, v79
    ds_write_b64 v4, v[82:83] offset:13600
    v_pk_mul_f32 v[72:73], v[64:65], v[40:41] op_sel:[0,0] op_sel_hi:[0,1]
    v_pk_fma_f32 v[68:69], v[64:65], v[40:41], v[72:73] op_sel:[1,1,0] op_sel_hi:[1,0,1] neg_lo:[1,0,0]
    v_pk_mul_f32 v[74:75], v[66:67], v[42:43] op_sel:[0,0] op_sel_hi:[0,1]
    v_pk_fma_f32 v[70:71], v[66:67], v[42:43], v[74:75] op_sel:[1,1,0] op_sel_hi:[1,0,1] neg_lo:[1,0,0]
    v_cvt_pk_bf16_f32 v80, v68, -v69
    v_cvt_pk_bf16_f32 v81, v70, -v71
    ds_write_b64 v4, v[80:81] offset:5440
    v_lshlrev_b32 v76, 16, v80
    v_and_b32 v77, s15, v80
    v_pk_add_f32 v[76:77], v[68:69], v[76:77] neg_lo:[0,1] neg_hi:[1,1]
    v_cvt_pk_bf16_f32 v82, v76, v77
    v_lshlrev_b32 v78, 16, v81
    v_and_b32 v79, s15, v81
    v_pk_add_f32 v[78:79], v[70:71], v[78:79] neg_lo:[0,1] neg_hi:[1,1]
    v_cvt_pk_bf16_f32 v83, v78, v79
    ds_write_b64 v4, v[82:83] offset:14144
    v_pk_mul_f32 v[72:73], v[64:65], v[44:45] op_sel:[0,0] op_sel_hi:[0,1]
    v_pk_fma_f32 v[68:69], v[64:65], v[44:45], v[72:73] op_sel:[1,1,0] op_sel_hi:[1,0,1] neg_lo:[1,0,0]
    v_pk_mul_f32 v[74:75], v[66:67], v[46:47] op_sel:[0,0] op_sel_hi:[0,1]
    v_pk_fma_f32 v[70:71], v[66:67], v[46:47], v[74:75] op_sel:[1,1,0] op_sel_hi:[1,0,1] neg_lo:[1,0,0]
    v_cvt_pk_bf16_f32 v80, v68, -v69
    v_cvt_pk_bf16_f32 v81, v70, -v71
    ds_write_b64 v4, v[80:81] offset:5984
    v_lshlrev_b32 v76, 16, v80
    v_and_b32 v77, s15, v80
    v_pk_add_f32 v[76:77], v[68:69], v[76:77] neg_lo:[0,1] neg_hi:[1,1]
    v_cvt_pk_bf16_f32 v82, v76, v77
    v_lshlrev_b32 v78, 16, v81
    v_and_b32 v79, s15, v81
    v_pk_add_f32 v[78:79], v[70:71], v[78:79] neg_lo:[0,1] neg_hi:[1,1]
    v_cvt_pk_bf16_f32 v83, v78, v79
    ds_write_b64 v4, v[82:83] offset:14688
    v_pk_mul_f32 v[72:73], v[64:65], v[48:49] op_sel:[0,0] op_sel_hi:[0,1]
    v_pk_fma_f32 v[68:69], v[64:65], v[48:49], v[72:73] op_sel:[1,1,0] op_sel_hi:[1,0,1] neg_lo:[1,0,0]
    v_pk_mul_f32 v[74:75], v[66:67], v[50:51] op_sel:[0,0] op_sel_hi:[0,1]
    v_pk_fma_f32 v[70:71], v[66:67], v[50:51], v[74:75] op_sel:[1,1,0] op_sel_hi:[1,0,1] neg_lo:[1,0,0]
    v_cvt_pk_bf16_f32 v80, v68, -v69
    v_cvt_pk_bf16_f32 v81, v70, -v71
    ds_write_b64 v4, v[80:81] offset:6528
    v_lshlrev_b32 v76, 16, v80
    v_and_b32 v77, s15, v80
    v_pk_add_f32 v[76:77], v[68:69], v[76:77] neg_lo:[0,1] neg_hi:[1,1]
    v_cvt_pk_bf16_f32 v82, v76, v77
    v_lshlrev_b32 v78, 16, v81
    v_and_b32 v79, s15, v81
    v_pk_add_f32 v[78:79], v[70:71], v[78:79] neg_lo:[0,1] neg_hi:[1,1]
    v_cvt_pk_bf16_f32 v83, v78, v79
    ds_write_b64 v4, v[82:83] offset:15232
    v_pk_mul_f32 v[72:73], v[64:65], v[52:53] op_sel:[0,0] op_sel_hi:[0,1]
    v_pk_fma_f32 v[68:69], v[64:65], v[52:53], v[72:73] op_sel:[1,1,0] op_sel_hi:[1,0,1] neg_lo:[1,0,0]
    v_pk_mul_f32 v[74:75], v[66:67], v[54:55] op_sel:[0,0] op_sel_hi:[0,1]
    v_pk_fma_f32 v[70:71], v[66:67], v[54:55], v[74:75] op_sel:[1,1,0] op_sel_hi:[1,0,1] neg_lo:[1,0,0]
    v_cvt_pk_bf16_f32 v80, v68, -v69
    v_cvt_pk_bf16_f32 v81, v70, -v71
    ds_write_b64 v4, v[80:81] offset:7072
    v_lshlrev_b32 v76, 16, v80
    v_and_b32 v77, s15, v80
    v_pk_add_f32 v[76:77], v[68:69], v[76:77] neg_lo:[0,1] neg_hi:[1,1]
    v_cvt_pk_bf16_f32 v82, v76, v77
    v_lshlrev_b32 v78, 16, v81
    v_and_b32 v79, s15, v81
    v_pk_add_f32 v[78:79], v[70:71], v[78:79] neg_lo:[0,1] neg_hi:[1,1]
    v_cvt_pk_bf16_f32 v83, v78, v79
    ds_write_b64 v4, v[82:83] offset:15776
    v_pk_mul_f32 v[72:73], v[64:65], v[56:57] op_sel:[0,0] op_sel_hi:[0,1]
    v_pk_fma_f32 v[68:69], v[64:65], v[56:57], v[72:73] op_sel:[1,1,0] op_sel_hi:[1,0,1] neg_lo:[1,0,0]
    v_pk_mul_f32 v[74:75], v[66:67], v[58:59] op_sel:[0,0] op_sel_hi:[0,1]
    v_pk_fma_f32 v[70:71], v[66:67], v[58:59], v[74:75] op_sel:[1,1,0] op_sel_hi:[1,0,1] neg_lo:[1,0,0]
    v_cvt_pk_bf16_f32 v80, v68, -v69
    v_cvt_pk_bf16_f32 v81, v70, -v71
    ds_write_b64 v4, v[80:81] offset:7616
    v_lshlrev_b32 v76, 16, v80
    v_and_b32 v77, s15, v80
    v_pk_add_f32 v[76:77], v[68:69], v[76:77] neg_lo:[0,1] neg_hi:[1,1]
    v_cvt_pk_bf16_f32 v82, v76, v77
    v_lshlrev_b32 v78, 16, v81
    v_and_b32 v79, s15, v81
    v_pk_add_f32 v[78:79], v[70:71], v[78:79] neg_lo:[0,1] neg_hi:[1,1]
    v_cvt_pk_bf16_f32 v83, v78, v79
    ds_write_b64 v4, v[82:83] offset:16320
    v_pk_mul_f32 v[72:73], v[64:65], v[60:61] op_sel:[0,0] op_sel_hi:[0,1]
    v_pk_fma_f32 v[68:69], v[64:65], v[60:61], v[72:73] op_sel:[1,1,0] op_sel_hi:[1,0,1] neg_lo:[1,0,0]
    v_pk_mul_f32 v[74:75], v[66:67], v[62:63] op_sel:[0,0] op_sel_hi:[0,1]
    v_pk_fma_f32 v[70:71], v[66:67], v[62:63], v[74:75] op_sel:[1,1,0] op_sel_hi:[1,0,1] neg_lo:[1,0,0]
    v_cvt_pk_bf16_f32 v80, v68, -v69
    v_cvt_pk_bf16_f32 v81, v70, -v71
    ds_write_b64 v4, v[80:81] offset:8160
    v_lshlrev_b32 v76, 16, v80
    v_and_b32 v77, s15, v80
    v_pk_add_f32 v[76:77], v[68:69], v[76:77] neg_lo:[0,1] neg_hi:[1,1]
    v_cvt_pk_bf16_f32 v82, v76, v77
    v_lshlrev_b32 v78, 16, v81
    v_and_b32 v79, s15, v81
    v_pk_add_f32 v[78:79], v[70:71], v[78:79] neg_lo:[0,1] neg_hi:[1,1]
    v_cvt_pk_bf16_f32 v83, v78, v79
    ds_write_b64 v4, v[82:83] offset:16864
    ds_read_b128 v[160:163], v7 offset:0
    ds_read_b128 v[164:167], v7 offset:8704
    ds_read_b128 v[168:171], v7 offset:64
    ds_read_b128 v[172:175], v7 offset:8768
    ds_read_b128 v[176:179], v7 offset:128
    ds_read_b128 v[180:183], v7 offset:8832
    ds_read_b128 v[184:187], v7 offset:192
    ds_read_b128 v[188:191], v7 offset:8896
    ds_read_b128 v[192:195], v7 offset:256
    ds_read_b128 v[196:199], v7 offset:8960
    ds_read_b128 v[200:203], v7 offset:320
    ds_read_b128 v[204:207], v7 offset:9024
    ds_read_b128 v[208:211], v7 offset:384
    ds_read_b128 v[212:215], v7 offset:9088
    ds_read_b128 v[216:219], v7 offset:448
    ds_read_b128 v[220:223], v7 offset:9152
    s_waitcnt lgkmcnt(14)
    v_mfma_f32_16x16x32_bf16 v[224:227], v[160:163], v[96:99], 0
    v_mfma_f32_16x16x32_bf16 v[224:227], v[160:163], v[100:103], v[224:227]
    v_mfma_f32_16x16x32_bf16 v[224:227], v[164:167], v[96:99], v[224:227]
    s_waitcnt lgkmcnt(12)
    v_mfma_f32_16x16x32_bf16 v[224:227], v[168:171], v[104:107], v[224:227]
    v_mfma_f32_16x16x32_bf16 v[224:227], v[168:171], v[108:111], v[224:227]
    v_mfma_f32_16x16x32_bf16 v[224:227], v[172:175], v[104:107], v[224:227]
    s_waitcnt lgkmcnt(10)
    v_mfma_f32_16x16x32_bf16 v[224:227], v[176:179], v[112:115], v[224:227]
    v_mfma_f32_16x16x32_bf16 v[224:227], v[176:179], v[116:119], v[224:227]
    v_mfma_f32_16x16x32_bf16 v[224:227], v[180:183], v[112:115], v[224:227]
    s_waitcnt lgkmcnt(8)
    v_mfma_f32_16x16x32_bf16 v[224:227], v[184:187], v[120:123], v[224:227]
    v_mfma_f32_16x16x32_bf16 v[224:227], v[184:187], v[124:127], v[224:227]
    v_mfma_f32_16x16x32_bf16 v[224:227], v[188:191], v[120:123], v[224:227]
    s_waitcnt lgkmcnt(6)
    v_mfma_f32_16x16x32_bf16 v[224:227], v[192:195], v[128:131], v[224:227]
    v_mfma_f32_16x16x32_bf16 v[224:227], v[192:195], v[132:135], v[224:227]
    v_mfma_f32_16x16x32_bf16 v[224:227], v[196:199], v[128:131], v[224:227]
    s_waitcnt lgkmcnt(4)
    v_mfma_f32_16x16x32_bf16 v[224:227], v[200:203], v[136:139], v[224:227]
    v_mfma_f32_16x16x32_bf16 v[224:227], v[200:203], v[140:143], v[224:227]
    v_mfma_f32_16x16x32_bf16 v[224:227], v[204:207], v[136:139], v[224:227]
    s_waitcnt lgkmcnt(2)
    v_mfma_f32_16x16x32_bf16 v[224:227], v[208:211], v[144:147], v[224:227]
    v_mfma_f32_16x16x32_bf16 v[224:227], v[208:211], v[148:151], v[224:227]
    v_mfma_f32_16x16x32_bf16 v[224:227], v[212:215], v[144:147], v[224:227]
    s_waitcnt lgkmcnt(0)
    v_mfma_f32_16x16x32_bf16 v[224:227], v[216:219], v[152:155], v[224:227]
    v_mfma_f32_16x16x32_bf16 v[224:227], v[216:219], v[156:159], v[224:227]
    v_mfma_f32_16x16x32_bf16 v[224:227], v[220:223], v[152:155], v[224:227]
    v_lshlrev_b32 v8, 5, v5
    v_add_u32 v8, s11, v8
    v_lshrrev_b32 v9, 1, v6
    v_lshlrev_b32 v9, 9, v9
    v_and_b32 v10, 1, v6
    v_lshlrev_b32 v10, 4, v10
    v_add3_u32 v9, v8, v9, v10
    s_nop 0
    ds_write_b32 v9, v224 offset:0
    ds_write_b32 v9, v225 offset:4
    ds_write_b32 v9, v226 offset:8
    ds_write_b32 v9, v227 offset:12
    s_cmp_ge_u32 s58, 196
    s_cbranch_scc1 K1_WDONE0
    v_lshrrev_b32 v236, 2, v5
    v_and_b32 v237, 1, v5
    v_lshlrev_b32 v237, 4, v237
    v_mov_b32 v238, 0x3f80
    v_lshlrev_b32 v237, v237, v238
    v_cmp_eq_u32 vcc, v236, v6
    s_nop 1
    v_cndmask_b32 v237, 0, v237, vcc
    v_bfe_u32 v238, v5, 1, 1
    v_cmp_eq_u32 vcc, 0, v238
    s_nop 1
    v_cndmask_b32 v160, 0, v237, vcc
    v_cndmask_b32 v161, v237, 0, vcc
    v_mov_b32 v162, 0
    v_mov_b32 v163, 0
    v_mov_b32 v164, 0
    v_mov_b32 v165, 0
    v_mov_b32 v166, v160
    v_mov_b32 v167, v161
    v_lshlrev_b32 v236, 4, v2
    v_add_u32 v236, s55, v236
    v_add_u32 v237, s50, v236
    s_waitcnt vmcnt(0)
    v_mfma_f32_16x16x32_bf16 v[168:171], v[240:243], v[160:163], 0
    v_mfma_f32_16x16x32_bf16 v[172:175], v[244:247], v[160:163], 0
    v_mfma_f32_16x16x32_bf16 v[176:179], v[240:243], v[164:167], 0
    v_mfma_f32_16x16x32_bf16 v[180:183], v[244:247], v[164:167], 0
    s_nop 4
    v_cvt_pk_bf16_f32 v184, v168, v169
    v_cvt_pk_bf16_f32 v185, v170, v171
    v_cvt_pk_bf16_f32 v186, v172, v173
    v_cvt_pk_bf16_f32 v187, v174, v175
    global_store_dwordx4 v236, v[184:187], s[32:33] sc1
    v_cvt_pk_bf16_f32 v188, v176, v177
    v_cvt_pk_bf16_f32 v189, v178, v179
    v_cvt_pk_bf16_f32 v190, v180, v181
    v_cvt_pk_bf16_f32 v191, v182, v183
    global_store_dwordx4 v237, v[188:191], s[32:33] sc1
K1_WDONE0:
    s_nop 1
    s_branch K1_EXP
K1_RB:
    v_mul_f32 v90, 2.0, v20
    v_mul_f32 v91, 2.0, v21
    v_exp_f32 v90, v90
    v_fract_f32 v91, v91
    v_cos_f32 v92, v91
    v_sin_f32 v93, v91
    v_mul_f32 v40, v90, v92
    v_mul_f32 v41, v90, v93
    v_mul_f32 v90, 2.0, v22
    v_mul_f32 v91, 2.0, v23
    v_exp_f32 v90, v90
    v_fract_f32 v91, v91
    v_cos_f32 v92, v91
    v_sin_f32 v93, v91
    v_mul_f32 v42, v90, v92
    v_mul_f32 v43, v90, v93
    v_pk_mul_f32 v[72:73], v[40:41], v[40:41] op_sel:[0,0] op_sel_hi:[0,1]
    v_pk_fma_f32 v[48:49], v[40:41], v[40:41], v[72:73] op_sel:[1,1,0] op_sel_hi:[1,0,1] neg_lo:[1,0,0]
    v_pk_mul_f32 v[74:75], v[42:43], v[42:43] op_sel:[0,0] op_sel_hi:[0,1]
    v_pk_fma_f32 v[50:51], v[42:43], v[42:43], v[74:75] op_sel:[1,1,0] op_sel_hi:[1,0,1] neg_lo:[1,0,0]
    v_pk_mul_f32 v[72:73], v[48:49], v[40:41] op_sel:[0,0] op_sel_hi:[0,1]
    v_pk_fma_f32 v[56:57], v[48:49], v[40:41], v[72:73] op_sel:[1,1,0] op_sel_hi:[1,0,1] neg_lo:[1,0,0]
    v_pk_mul_f32 v[74:75], v[50:51], v[42:43] op_sel:[0,0] op_sel_hi:[0,1]
    v_pk_fma_f32 v[58:59], v[50:51], v[42:43], v[74:75] op_sel:[1,1,0] op_sel_hi:[1,0,1] neg_lo:[1,0,0]
    v_pk_mul_f32 v[72:73], v[24:25], v[36:37] op_sel:[0,0] op_sel_hi:[0,1]
    v_pk_fma_f32 v[64:65], v[24:25], v[36:37], v[72:73] op_sel:[1,1,0] op_sel_hi:[1,0,1] neg_lo:[1,0,0]
    v_pk_mul_f32 v[74:75], v[26:27], v[38:39] op_sel:[0,0] op_sel_hi:[0,1]
    v_pk_fma_f32 v[66:67], v[26:27], v[38:39], v[74:75] op_sel:[1,1,0] op_sel_hi:[1,0,1] neg_lo:[1,0,0]
    v_pk_mul_f32 v[72:73], v[64:65], v[36:37] op_sel:[0,0] op_sel_hi:[0,1]
    v_pk_fma_f32 v[64:65], v[64:65], v[36:37], v[72:73] op_sel:[1,1,0] op_sel_hi:[1,0,1] neg_lo:[1,0,0]
    v_pk_mul_f32 v[74:75], v[66:67], v[38:39] op_sel:[0,0] op_sel_hi:[0,1]
    v_pk_fma_f32 v[66:67], v[66:67], v[38:39], v[74:75] op_sel:[1,1,0] op_sel_hi:[1,0,1] neg_lo:[1,0,0]
    v_cvt_pk_bf16_f32 v80, v64, -v65
    v_cvt_pk_bf16_f32 v81, v66, -v67
    ds_write_b64 v4, v[80:81] offset:0
    v_lshlrev_b32 v76, 16, v80
    v_and_b32 v77, s15, v80
    v_pk_add_f32 v[76:77], v[64:65], v[76:77] neg_lo:[0,1] neg_hi:[1,1]
    v_cvt_pk_bf16_f32 v82, v76, v77
    v_lshlrev_b32 v78, 16, v81
    v_and_b32 v79, s15, v81
    v_pk_add_f32 v[78:79], v[66:67], v[78:79] neg_lo:[0,1] neg_hi:[1,1]
    v_cvt_pk_bf16_f32 v83, v78, v79
    ds_write_b64 v4, v[82:83] offset:8704
    v_pk_mul_f32 v[72:73], v[64:65], v[40:41] op_sel:[0,0] op_sel_hi:[0,1]
    v_pk_fma_f32 v[68:69], v[64:65], v[40:41], v[72:73] op_sel:[1,1,0] op_sel_hi:[1,0,1] neg_lo:[1,0,0]
    v_pk_mul_f32 v[74:75], v[66:67], v[42:43] op_sel:[0,0] op_sel_hi:[0,1]
    v_pk_fma_f32 v[70:71], v[66:67], v[42:43], v[74:75] op_sel:[1,1,0] op_sel_hi:[1,0,1] neg_lo:[1,0,0]
    v_cvt_pk_bf16_f32 v80, v68, -v69
    v_cvt_pk_bf16_f32 v81, v70, -v71
    ds_write_b64 v4, v[80:81] offset:544
    v_lshlrev_b32 v76, 16, v80
    v_and_b32 v77, s15, v80
    v_pk_add_f32 v[76:77], v[68:69], v[76:77] neg_lo:[0,1] neg_hi:[1,1]
    v_cvt_pk_bf16_f32 v82, v76, v77
    v_lshlrev_b32 v78, 16, v81
    v_and_b32 v79, s15, v81
    v_pk_add_f32 v[78:79], v[70:71], v[78:79] neg_lo:[0,1] neg_hi:[1,1]
    v_cvt_pk_bf16_f32 v83, v78, v79
    ds_write_b64 v4, v[82:83] offset:9248
    v_pk_mul_f32 v[72:73], v[64:65], v[48:49] op_sel:[0,0] op_sel_hi:[0,1]
    v_pk_fma_f32 v[68:69], v[64:65], v[48:49], v[72:73] op_sel:[1,1,0] op_sel_hi:[1,0,1] neg_lo:[1,0,0]
    v_pk_mul_f32 v[74:75], v[66:67], v[50:51] op_sel:[0,0] op_sel_hi:[0,1]
    v_pk_fma_f32 v[70:71], v[66:67], v[50:51], v[74:75] op_sel:[1,1,0] op_sel_hi:[1,0,1] neg_lo:[1,0,0]
    global_load_dword v248, v252, s[16:17] offset:0
    v_cvt_pk_bf16_f32 v80, v68, -v69
    v_cvt_pk_bf16_f32 v81, v70, -v71
    ds_write_b64 v4, v[80:81] offset:1088
    v_lshlrev_b32 v76, 16, v80
    v_and_b32 v77, s15, v80
    v_pk_add_f32 v[76:77], v[68:69], v[76:77] neg_lo:[0,1] neg_hi:[1,1]
    v_cvt_pk_bf16_f32 v82, v76, v77
    v_lshlrev_b32 v78, 16, v81
    v_and_b32 v79, s15, v81
    v_pk_add_f32 v[78:79], v[70:71], v[78:79] neg_lo:[0,1] neg_hi:[1,1]
    v_cvt_pk_bf16_f32 v83, v78, v79
    ds_write_b64 v4, v[82:83] offset:9792
    v_pk_mul_f32 v[72:73], v[64:65], v[56:57] op_sel:[0,0] op_sel_hi:[0,1]
    v_pk_fma_f32 v[68:69], v[64:65], v[56:57], v[72:73] op_sel:[1,1,0] op_sel_hi:[1,0,1] neg_lo:[1,0,0]
    v_pk_mul_f32 v[74:75], v[66:67], v[58:59] op_sel:[0,0] op_sel_hi:[0,1]
    v_pk_fma_f32 v[70:71], v[66:67], v[58:59], v[74:75] op_sel:[1,1,0] op_sel_hi:[1,0,1] neg_lo:[1,0,0]
    v_cvt_pk_bf16_f32 v80, v68, -v69
    v_cvt_pk_bf16_f32 v81, v70, -v71
    ds_write_b64 v4, v[80:81] offset:1632
    v_lshlrev_b32 v76, 16, v80
    v_and_b32 v77, s15, v80
    v_pk_add_f32 v[76:77], v[68:69], v[76:77] neg_lo:[0,1] neg_hi:[1,1]
    v_cvt_pk_bf16_f32 v82, v76, v77
    v_lshlrev_b32 v78, 16, v81
    v_and_b32 v79, s15, v81
    v_pk_add_f32 v[78:79], v[70:71], v[78:79] neg_lo:[0,1] neg_hi:[1,1]
    v_cvt_pk_bf16_f32 v83, v78, v79
    ds_write_b64 v4, v[82:83] offset:10336
    v_pk_mul_f32 v[72:73], v[64:65], v[36:37] op_sel:[0,0] op_sel_hi:[0,1]
    v_pk_fma_f32 v[64:65], v[64:65], v[36:37], v[72:73] op_sel:[1,1,0] op_sel_hi:[1,0,1] neg_lo:[1,0,0]
    v_pk_mul_f32 v[74:75], v[66:67], v[38:39] op_sel:[0,0] op_sel_hi:[0,1]
    v_pk_fma_f32 v[66:67], v[66:67], v[38:39], v[74:75] op_sel:[1,1,0] op_sel_hi:[1,0,1] neg_lo:[1,0,0]
    v_cvt_pk_bf16_f32 v80, v64, -v65
    v_cvt_pk_bf16_f32 v81, v66, -v67
    ds_write_b64 v4, v[80:81] offset:2176
    v_lshlrev_b32 v76, 16, v80
    v_and_b32 v77, s15, v80
    v_pk_add_f32 v[76:77], v[64:65], v[76:77] neg_lo:[0,1] neg_hi:[1,1]
    v_cvt_pk_bf16_f32 v82, v76, v77
    v_lshlrev_b32 v78, 16, v81
    v_and_b32 v79, s15, v81
    v_pk_add_f32 v[78:79], v[66:67], v[78:79] neg_lo:[0,1] neg_hi:[1,1]
    v_cvt_pk_bf16_f32 v83, v78, v79
    ds_write_b64 v4, v[82:83] offset:10880
    v_pk_mul_f32 v[72:73], v[64:65], v[40:41] op_sel:[0,0] op_sel_hi:[0,1]
    v_pk_fma_f32 v[68:69], v[64:65], v[40:41], v[72:73] op_sel:[1,1,0] op_sel_hi:[1,0,1] neg_lo:[1,0,0]
    v_pk_mul_f32 v[74:75], v[66:67], v[42:43] op_sel:[0,0] op_sel_hi:[0,1]
    v_pk_fma_f32 v[70:71], v[66:67], v[42:43], v[74:75] op_sel:[1,1,0] op_sel_hi:[1,0,1] neg_lo:[1,0,0]
    v_cvt_pk_bf16_f32 v80, v68, -v69
    v_cvt_pk_bf16_f32 v81, v70, -v71
    ds_write_b64 v4, v[80:81] offset:2720
    v_lshlrev_b32 v76, 16, v80
    v_and_b32 v77, s15, v80
    v_pk_add_f32 v[76:77], v[68:69], v[76:77] neg_lo:[0,1] neg_hi:[1,1]
    v_cvt_pk_bf16_f32 v82, v76, v77
    v_lshlrev_b32 v78, 16, v81
    v_and_b32 v79, s15, v81
    v_pk_add_f32 v[78:79], v[70:71], v[78:79] neg_lo:[0,1] neg_hi:[1,1]
    v_cvt_pk_bf16_f32 v83, v78, v79
    ds_write_b64 v4, v[82:83] offset:11424
    v_pk_mul_f32 v[72:73], v[64:65], v[48:49] op_sel:[0,0] op_sel_hi:[0,1]
    v_pk_fma_f32 v[68:69], v[64:65], v[48:49], v[72:73] op_sel:[1,1,0] op_sel_hi:[1,0,1] neg_lo:[1,0,0]
    v_pk_mul_f32 v[74:75], v[66:67], v[50:51] op_sel:[0,0] op_sel_hi:[0,1]
    v_pk_fma_f32 v[70:71], v[66:67], v[50:51], v[74:75] op_sel:[1,1,0] op_sel_hi:[1,0,1] neg_lo:[1,0,0]
    v_cvt_pk_bf16_f32 v80, v68, -v69
    v_cvt_pk_bf16_f32 v81, v70, -v71
    ds_write_b64 v4, v[80:81] offset:3264
    v_lshlrev_b32 v76, 16, v80
    v_and_b32 v77, s15, v80
    v_pk_add_f32 v[76:77], v[68:69], v[76:77] neg_lo:[0,1] neg_hi:[1,1]
    v_cvt_pk_bf16_f32 v82, v76, v77
    v_lshlrev_b32 v78, 16, v81
    v_and_b32 v79, s15, v81
    v_pk_add_f32 v[78:79], v[70:71], v[78:79] neg_lo:[0,1] neg_hi:[1,1]
    v_cvt_pk_bf16_f32 v83, v78, v79
    ds_write_b64 v4, v[82:83] offset:11968
    v_pk_mul_f32 v[72:73], v[64:65], v[56:57] op_sel:[0,0] op_sel_hi:[0,1]
    v_pk_fma_f32 v[68:69], v[64:65], v[56:57], v[72:73] op_sel:[1,1,0] op_sel_hi:[1,0,1] neg_lo:[1,0,0]
    v_pk_mul_f32 v[74:75], v[66:67], v[58:59] op_sel:[0,0] op_sel_hi:[0,1]
    v_pk_fma_f32 v[70:71], v[66:67], v[58:59], v[74:75] op_sel:[1,1,0] op_sel_hi:[1,0,1] neg_lo:[1,0,0]
    global_load_dword v249, v252, s[16:17] offset:896
    v_cvt_pk_bf16_f32 v80, v68, -v69
    v_cvt_pk_bf16_f32 v81, v70, -v71
    ds_write_b64 v4, v[80:81] offset:3808
    v_lshlrev_b32 v76, 16, v80
    v_and_b32 v77, s15, v80
    v_pk_add_f32 v[76:77], v[68:69], v[76:77] neg_lo:[0,1] neg_hi:[1,1]
    v_cvt_pk_bf16_f32 v82, v76, v77
    v_lshlrev_b32 v78, 16, v81
    v_and_b32 v79, s15, v81
    v_pk_add_f32 v[78:79], v[70:71], v[78:79] neg_lo:[0,1] neg_hi:[1,1]
    v_cvt_pk_bf16_f32 v83, v78, v79
    ds_write_b64 v4, v[82:83] offset:12512
    v_pk_mul_f32 v[72:73], v[64:65], v[36:37] op_sel:[0,0] op_sel_hi:[0,1]
    v_pk_fma_f32 v[64:65], v[64:65], v[36:37], v[72:73] op_sel:[1,1,0] op_sel_hi:[1,0,1] neg_lo:[1,0,0]
    v_pk_mul_f32 v[74:75], v[66:67], v[38:39] op_sel:[0,0] op_sel_hi:[0,1]
    v_pk_fma_f32 v[66:67], v[66:67], v[38:39], v[74:75] op_sel:[1,1,0] op_sel_hi:[1,0,1] neg_lo:[1,0,0]
    v_cvt_pk_bf16_f32 v80, v64, -v65
    v_cvt_pk_bf16_f32 v81, v66, -v67
    ds_write_b64 v4, v[80:81] offset:4352
    v_lshlrev_b32 v76, 16, v80
    v_and_b32 v77, s15, v80
    v_pk_add_f32 v[76:77], v[64:65], v[76:77] neg_lo:[0,1] neg_hi:[1,1]
    v_cvt_pk_bf16_f32 v82, v76, v77
    v_lshlrev_b32 v78, 16, v81
    v_and_b32 v79, s15, v81
    v_pk_add_f32 v[78:79], v[66:67], v[78:79] neg_lo:[0,1] neg_hi:[1,1]
    v_cvt_pk_bf16_f32 v83, v78, v79
    ds_write_b64 v4, v[82:83] offset:13056
    v_pk_mul_f32 v[72:73], v[64:65], v[48:49] op_sel:[0,0] op_sel_hi:[0,1]
    v_pk_fma_f32 v[68:69], v[64:65], v[48:49], v[72:73] op_sel:[1,1,0] op_sel_hi:[1,0,1] neg_lo:[1,0,0]
    v_pk_mul_f32 v[74:75], v[66:67], v[50:51] op_sel:[0,0] op_sel_hi:[0,1]
    v_pk_fma_f32 v[70:71], v[66:67], v[50:51], v[74:75] op_sel:[1,1,0] op_sel_hi:[1,0,1] neg_lo:[1,0,0]
    v_cvt_pk_bf16_f32 v80, v68, -v69
    v_cvt_pk_bf16_f32 v81, v70, -v71
    ds_write_b64 v4, v[80:81] offset:6528
    v_lshlrev_b32 v76, 16, v80
    v_and_b32 v77, s15, v80
    v_pk_add_f32 v[76:77], v[68:69], v[76:77] neg_lo:[0,1] neg_hi:[1,1]
    v_cvt_pk_bf16_f32 v82, v76, v77
    v_lshlrev_b32 v78, 16, v81
    v_and_b32 v79, s15, v81
    v_pk_add_f32 v[78:79], v[70:71], v[78:79] neg_lo:[0,1] neg_hi:[1,1]
    v_cvt_pk_bf16_f32 v83, v78, v79
    ds_write_b64 v4, v[82:83] offset:15232
    v_pk_mul_f32 v[72:73], v[64:65], v[36:37] op_sel:[0,0] op_sel_hi:[0,1]
    v_pk_fma_f32 v[64:65], v[64:65], v[36:37], v[72:73] op_sel:[1,1,0] op_sel_hi:[1,0,1] neg_lo:[1,0,0]
    v_pk_mul_f32 v[74:75], v[66:67], v[38:39] op_sel:[0,0] op_sel_hi:[0,1]
    v_pk_fma_f32 v[66:67], v[66:67], v[38:39], v[74:75] op_sel:[1,1,0] op_sel_hi:[1,0,1] neg_lo:[1,0,0]
    v_cvt_pk_bf16_f32 v80, v64, -v65
    v_cvt_pk_bf16_f32 v81, v66, -v67
    ds_write_b64 v4, v[80:81] offset:4896
    v_lshlrev_b32 v76, 16, v80
    v_and_b32 v77, s15, v80
    v_pk_add_f32 v[76:77], v[64:65], v[76:77] neg_lo:[0,1] neg_hi:[1,1]
    v_cvt_pk_bf16_f32 v82, v76, v77
    v_lshlrev_b32 v78, 16, v81
    v_and_b32 v79, s15, v81
    v_pk_add_f32 v[78:79], v[66:67], v[78:79] neg_lo:[0,1] neg_hi:[1,1]
    v_cvt_pk_bf16_f32 v83, v78, v79
    ds_write_b64 v4, v[82:83] offset:13600
    v_pk_mul_f32 v[72:73], v[64:65], v[48:49] op_sel:[0,0] op_sel_hi:[0,1]
    v_pk_fma_f32 v[68:69], v[64:65], v[48:49], v[72:73] op_sel:[1,1,0] op_sel_hi:[1,0,1] neg_lo:[1,0,0]
    v_pk_mul_f32 v[74:75], v[66:67], v[50:51] op_sel:[0,0] op_sel_hi:[0,1]
    v_pk_fma_f32 v[70:71], v[66:67], v[50:51], v[74:75] op_sel:[1,1,0] op_sel_hi:[1,0,1] neg_lo:[1,0,0]
    v_cvt_pk_bf16_f32 v80, v68, -v69
    v_cvt_pk_bf16_f32 v81, v70, -v71
    ds_write_b64 v4, v[80:81] offset:7072
    v_lshlrev_b32 v76, 16, v80
    v_and_b32 v77, s15, v80
    v_pk_add_f32 v[76:77], v[68:69], v[76:77] neg_lo:[0,1] neg_hi:[1,1]
    v_cvt_pk_bf16_f32 v82, v76, v77
    v_lshlrev_b32 v78, 16, v81
    v_and_b32 v79, s15, v81
    v_pk_add_f32 v[78:79], v[70:71], v[78:79] neg_lo:[0,1] neg_hi:[1,1]
    v_cvt_pk_bf16_f32 v83, v78, v79
    ds_write_b64 v4, v[82:83] offset:15776
    v_pk_mul_f32 v[72:73], v[64:65], v[36:37] op_sel:[0,0] op_sel_hi:[0,1]
    v_pk_fma_f32 v[64:65], v[64:65], v[36:37], v[72:73] op_sel:[1,1,0] op_sel_hi:[1,0,1] neg_lo:[1,0,0]
    v_pk_mul_f32 v[74:75], v[66:67], v[38:39] op_sel:[0,0] op_sel_hi:[0,1]
    v_pk_fma_f32 v[66:67], v[66:67], v[38:39], v[74:75] op_sel:[1,1,0] op_sel_hi:[1,0,1] neg_lo:[1,0,0]
    global_load_dword v250, v252, s[16:17] offset:1792
    v_cvt_pk_bf16_f32 v80, v64, -v65
    v_cvt_pk_bf16_f32 v81, v66, -v67
    ds_write_b64 v4, v[80:81] offset:5440
    v_lshlrev_b32 v76, 16, v80
    v_and_b32 v77, s15, v80
    v_pk_add_f32 v[76:77], v[64:65], v[76:77] neg_lo:[0,1] neg_hi:[1,1]
    v_cvt_pk_bf16_f32 v82, v76, v77
    v_lshlrev_b32 v78, 16, v81
    v_and_b32 v79, s15, v81
    v_pk_add_f32 v[78:79], v[66:67], v[78:79] neg_lo:[0,1] neg_hi:[1,1]
    v_cvt_pk_bf16_f32 v83, v78, v79
    ds_write_b64 v4, v[82:83] offset:14144
    v_pk_mul_f32 v[72:73], v[64:65], v[48:49] op_sel:[0,0] op_sel_hi:[0,1]
    v_pk_fma_f32 v[68:69], v[64:65], v[48:49], v[72:73] op_sel:[1,1,0] op_sel_hi:[1,0,1] neg_lo:[1,0,0]
    v_pk_mul_f32 v[74:75], v[66:67], v[50:51] op_sel:[0,0] op_sel_hi:[0,1]
    v_pk_fma_f32 v[70:71], v[66:67], v[50:51], v[74:75] op_sel:[1,1,0] op_sel_hi:[1,0,1] neg_lo:[1,0,0]
    v_cvt_pk_bf16_f32 v80, v68, -v69
    v_cvt_pk_bf16_f32 v81, v70, -v71
    ds_write_b64 v4, v[80:81] offset:7616
    v_lshlrev_b32 v76, 16, v80
    v_and_b32 v77, s15, v80
    v_pk_add_f32 v[76:77], v[68:69], v[76:77] neg_lo:[0,1] neg_hi:[1,1]
    v_cvt_pk_bf16_f32 v82, v76, v77
    v_lshlrev_b32 v78, 16, v81
    v_and_b32 v79, s15, v81
    v_pk_add_f32 v[78:79], v[70:71], v[78:79] neg_lo:[0,1] neg_hi:[1,1]
    v_cvt_pk_bf16_f32 v83, v78, v79
    ds_write_b64 v4, v[82:83] offset:16320
    v_pk_mul_f32 v[72:73], v[64:65], v[36:37] op_sel:[0,0] op_sel_hi:[0,1]
    v_pk_fma_f32 v[64:65], v[64:65], v[36:37], v[72:73] op_sel:[1,1,0] op_sel_hi:[1,0,1] neg_lo:[1,0,0]
    v_pk_mul_f32 v[74:75], v[66:67], v[38:39] op_sel:[0,0] op_sel_hi:[0,1]
    v_pk_fma_f32 v[66:67], v[66:67], v[38:39], v[74:75] op_sel:[1,1,0] op_sel_hi:[1,0,1] neg_lo:[1,0,0]
    v_cvt_pk_bf16_f32 v80, v64, -v65
    v_cvt_pk_bf16_f32 v81, v66, -v67
    ds_write_b64 v4, v[80:81] offset:5984
    v_lshlrev_b32 v76, 16, v80
    v_and_b32 v77, s15, v80
    v_pk_add_f32 v[76:77], v[64:65], v[76:77] neg_lo:[0,1] neg_hi:[1,1]
    v_cvt_pk_bf16_f32 v82, v76, v77
    v_lshlrev_b32 v78, 16, v81
    v_and_b32 v79, s15, v81
    v_pk_add_f32 v[78:79], v[66:67], v[78:79] neg_lo:[0,1] neg_hi:[1,1]
    v_cvt_pk_bf16_f32 v83, v78, v79
    ds_write_b64 v4, v[82:83] offset:14688
    v_pk_mul_f32 v[72:73], v[64:65], v[48:49] op_sel:[0,0] op_sel_hi:[0,1]
    v_pk_fma_f32 v[68:69], v[64:65], v[48:49], v[72:73] op_sel:[1,1,0] op_sel_hi:[1,0,1] neg_lo:[1,0,0]
    v_pk_mul_f32 v[74:75], v[66:67], v[50:51] op_sel:[0,0] op_sel_hi:[0,1]
    v_pk_fma_f32 v[70:71], v[66:67], v[50:51], v[74:75] op_sel:[1,1,0] op_sel_hi:[1,0,1] neg_lo:[1,0,0]
    v_cvt_pk_bf16_f32 v80, v68, -v69
    v_cvt_pk_bf16_f32 v81, v70, -v71
    ds_write_b64 v4, v[80:81] offset:8160
    v_lshlrev_b32 v76, 16, v80
    v_and_b32 v77, s15, v80
    v_pk_add_f32 v[76:77], v[68:69], v[76:77] neg_lo:[0,1] neg_hi:[1,1]
    v_cvt_pk_bf16_f32 v82, v76, v77
    v_lshlrev_b32 v78, 16, v81
    v_and_b32 v79, s15, v81
    v_pk_add_f32 v[78:79], v[70:71], v[78:79] neg_lo:[0,1] neg_hi:[1,1]
    v_cvt_pk_bf16_f32 v83, v78, v79
    ds_write_b64 v4, v[82:83] offset:16864
    s_waitcnt lgkmcnt(0)
    s_barrier
    ds_read_b128 v[96:99], v9 offset:0
    ds_read_b128 v[100:103], v9 offset:8704
    ds_read_b128 v[104:107], v9 offset:64
    ds_read_b128 v[108:111], v9 offset:8768
    ds_read_b128 v[112:115], v9 offset:128
    ds_read_b128 v[116:119], v9 offset:8832
    ds_read_b128 v[120:123], v9 offset:192
    ds_read_b128 v[124:127], v9 offset:8896
    ds_read_b128 v[128:131], v9 offset:256
    ds_read_b128 v[132:135], v9 offset:8960
    ds_read_b128 v[136:139], v9 offset:320
    ds_read_b128 v[140:143], v9 offset:9024
    ds_read_b128 v[144:147], v9 offset:384
    ds_read_b128 v[148:151], v9 offset:9088
    ds_read_b128 v[152:155], v9 offset:448
    ds_read_b128 v[156:159], v9 offset:9152
    s_waitcnt lgkmcnt(0)
    s_barrier
    ds_read_b128 v[160:163], v7 offset:0
    ds_read_b128 v[164:167], v7 offset:8704
    ds_read_b128 v[168:171], v7 offset:64
    ds_read_b128 v[172:175], v7 offset:8768
    ds_read_b128 v[176:179], v7 offset:128
    ds_read_b128 v[180:183], v7 offset:8832
    ds_read_b128 v[184:187], v7 offset:192
    ds_read_b128 v[188:191], v7 offset:8896
    ds_read_b128 v[192:195], v7 offset:256
    ds_read_b128 v[196:199], v7 offset:8960
    ds_read_b128 v[200:203], v7 offset:320
    ds_read_b128 v[204:207], v7 offset:9024
    ds_read_b128 v[208:211], v7 offset:384
    ds_read_b128 v[212:215], v7 offset:9088
    ds_read_b128 v[216:219], v7 offset:448
    ds_read_b128 v[220:223], v7 offset:9152
    s_waitcnt lgkmcnt(14)
    v_mfma_f32_16x16x32_bf16 v[228:231], v[160:163], v[96:99], 0
    v_mfma_f32_16x16x32_bf16 v[228:231], v[160:163], v[100:103], v[228:231]
    v_mfma_f32_16x16x32_bf16 v[228:231], v[164:167], v[96:99], v[228:231]
    s_waitcnt lgkmcnt(12)
    v_mfma_f32_16x16x32_bf16 v[228:231], v[168:171], v[104:107], v[228:231]
    v_mfma_f32_16x16x32_bf16 v[228:231], v[168:171], v[108:111], v[228:231]
    v_mfma_f32_16x16x32_bf16 v[228:231], v[172:175], v[104:107], v[228:231]
    s_waitcnt lgkmcnt(10)
    v_mfma_f32_16x16x32_bf16 v[228:231], v[176:179], v[112:115], v[228:231]
    v_mfma_f32_16x16x32_bf16 v[228:231], v[176:179], v[116:119], v[228:231]
    v_mfma_f32_16x16x32_bf16 v[228:231], v[180:183], v[112:115], v[228:231]
    s_waitcnt lgkmcnt(8)
    v_mfma_f32_16x16x32_bf16 v[228:231], v[184:187], v[120:123], v[228:231]
    v_mfma_f32_16x16x32_bf16 v[228:231], v[184:187], v[124:127], v[228:231]
    v_mfma_f32_16x16x32_bf16 v[228:231], v[188:191], v[120:123], v[228:231]
    s_waitcnt lgkmcnt(6)
    v_mfma_f32_16x16x32_bf16 v[228:231], v[192:195], v[128:131], v[228:231]
    v_mfma_f32_16x16x32_bf16 v[228:231], v[192:195], v[132:135], v[228:231]
    v_mfma_f32_16x16x32_bf16 v[228:231], v[196:199], v[128:131], v[228:231]
    s_waitcnt lgkmcnt(4)
    v_mfma_f32_16x16x32_bf16 v[228:231], v[200:203], v[136:139], v[228:231]
    v_mfma_f32_16x16x32_bf16 v[228:231], v[200:203], v[140:143], v[228:231]
    v_mfma_f32_16x16x32_bf16 v[228:231], v[204:207], v[136:139], v[228:231]
    s_waitcnt lgkmcnt(2)
    v_mfma_f32_16x16x32_bf16 v[228:231], v[208:211], v[144:147], v[228:231]
    v_mfma_f32_16x16x32_bf16 v[228:231], v[208:211], v[148:151], v[228:231]
    v_mfma_f32_16x16x32_bf16 v[228:231], v[212:215], v[144:147], v[228:231]
    s_waitcnt lgkmcnt(0)
    v_mfma_f32_16x16x32_bf16 v[228:231], v[216:219], v[152:155], v[228:231]
    v_mfma_f32_16x16x32_bf16 v[228:231], v[216:219], v[156:159], v[228:231]
    v_mfma_f32_16x16x32_bf16 v[228:231], v[220:223], v[152:155], v[228:231]
    v_pk_mul_f32 v[72:73], v[64:65], v[36:37] op_sel:[0,0] op_sel_hi:[0,1]
    v_pk_fma_f32 v[64:65], v[64:65], v[36:37], v[72:73] op_sel:[1,1,0] op_sel_hi:[1,0,1] neg_lo:[1,0,0]
    v_pk_mul_f32 v[74:75], v[66:67], v[38:39] op_sel:[0,0] op_sel_hi:[0,1]
    v_pk_fma_f32 v[66:67], v[66:67], v[38:39], v[74:75] op_sel:[1,1,0] op_sel_hi:[1,0,1] neg_lo:[1,0,0]
    v_cvt_pk_bf16_f32 v80, v64, -v65
    v_cvt_pk_bf16_f32 v81, v66, -v67
    ds_write_b64 v4, v[80:81] offset:0
    v_lshlrev_b32 v76, 16, v80
    v_and_b32 v77, s15, v80
    v_pk_add_f32 v[76:77], v[64:65], v[76:77] neg_lo:[0,1] neg_hi:[1,1]
    v_cvt_pk_bf16_f32 v82, v76, v77
    v_lshlrev_b32 v78, 16, v81
    v_and_b32 v79, s15, v81
    v_pk_add_f32 v[78:79], v[66:67], v[78:79] neg_lo:[0,1] neg_hi:[1,1]
    v_cvt_pk_bf16_f32 v83, v78, v79
    ds_write_b64 v4, v[82:83] offset:8704
    v_pk_mul_f32 v[72:73], v[64:65], v[36:37] op_sel:[0,0] op_sel_hi:[0,1]
    v_pk_fma_f32 v[64:65], v[64:65], v[36:37], v[72:73] op_sel:[1,1,0] op_sel_hi:[1,0,1] neg_lo:[1,0,0]
    v_pk_mul_f32 v[74:75], v[66:67], v[38:39] op_sel:[0,0] op_sel_hi:[0,1]
    v_pk_fma_f32 v[66:67], v[66:67], v[38:39], v[74:75] op_sel:[1,1,0] op_sel_hi:[1,0,1] neg_lo:[1,0,0]
    global_load_dword v251, v252, s[16:17] offset:2688
    v_cvt_pk_bf16_f32 v80, v64, -v65
    v_cvt_pk_bf16_f32 v81, v66, -v67
    ds_write_b64 v4, v[80:81] offset:544
    v_lshlrev_b32 v76, 16, v80
    v_and_b32 v77, s15, v80
    v_pk_add_f32 v[76:77], v[64:65], v[76:77] neg_lo:[0,1] neg_hi:[1,1]
    v_cvt_pk_bf16_f32 v82, v76, v77
    v_lshlrev_b32 v78, 16, v81
    v_and_b32 v79, s15, v81
    v_pk_add_f32 v[78:79], v[66:67], v[78:79] neg_lo:[0,1] neg_hi:[1,1]
    v_cvt_pk_bf16_f32 v83, v78, v79
    ds_write_b64 v4, v[82:83] offset:9248
    v_pk_mul_f32 v[72:73], v[64:65], v[36:37] op_sel:[0,0] op_sel_hi:[0,1]
    v_pk_fma_f32 v[64:65], v[64:65], v[36:37], v[72:73] op_sel:[1,1,0] op_sel_hi:[1,0,1] neg_lo:[1,0,0]
    v_pk_mul_f32 v[74:75], v[66:67], v[38:39] op_sel:[0,0] op_sel_hi:[0,1]
    v_pk_fma_f32 v[66:67], v[66:67], v[38:39], v[74:75] op_sel:[1,1,0] op_sel_hi:[1,0,1] neg_lo:[1,0,0]
    v_cvt_pk_bf16_f32 v80, v64, -v65
    v_cvt_pk_bf16_f32 v81, v66, -v67
    ds_write_b64 v4, v[80:81] offset:1088
    v_lshlrev_b32 v76, 16, v80
    v_and_b32 v77, s15, v80
    v_pk_add_f32 v[76:77], v[64:65], v[76:77] neg_lo:[0,1] neg_hi:[1,1]
    v_cvt_pk_bf16_f32 v82, v76, v77
    v_lshlrev_b32 v78, 16, v81
    v_and_b32 v79, s15, v81
    v_pk_add_f32 v[78:79], v[66:67], v[78:79] neg_lo:[0,1] neg_hi:[1,1]
    v_cvt_pk_bf16_f32 v83, v78, v79
    ds_write_b64 v4, v[82:83] offset:9792
    v_pk_mul_f32 v[72:73], v[64:65], v[36:37] op_sel:[0,0] op_sel_hi:[0,1]
    v_pk_fma_f32 v[64:65], v[64:65], v[36:37], v[72:73] op_sel:[1,1,0] op_sel_hi:[1,0,1] neg_lo:[1,0,0]
    v_pk_mul_f32 v[74:75], v[66:67], v[38:39] op_sel:[0,0] op_sel_hi:[0,1]
    v_pk_fma_f32 v[66:67], v[66:67], v[38:39], v[74:75] op_sel:[1,1,0] op_sel_hi:[1,0,1] neg_lo:[1,0,0]
    v_cvt_pk_bf16_f32 v80, v64, -v65
    v_cvt_pk_bf16_f32 v81, v66, -v67
    ds_write_b64 v4, v[80:81] offset:1632
    v_lshlrev_b32 v76, 16, v80
    v_and_b32 v77, s15, v80
    v_pk_add_f32 v[76:77], v[64:65], v[76:77] neg_lo:[0,1] neg_hi:[1,1]
    v_cvt_pk_bf16_f32 v82, v76, v77
    v_lshlrev_b32 v78, 16, v81
    v_and_b32 v79, s15, v81
    v_pk_add_f32 v[78:79], v[66:67], v[78:79] neg_lo:[0,1] neg_hi:[1,1]
    v_cvt_pk_bf16_f32 v83, v78, v79
    ds_write_b64 v4, v[82:83] offset:10336
    v_pk_mul_f32 v[72:73], v[64:65], v[36:37] op_sel:[0,0] op_sel_hi:[0,1]
    v_pk_fma_f32 v[64:65], v[64:65], v[36:37], v[72:73] op_sel:[1,1,0] op_sel_hi:[1,0,1] neg_lo:[1,0,0]
    v_pk_mul_f32 v[74:75], v[66:67], v[38:39] op_sel:[0,0] op_sel_hi:[0,1]
    v_pk_fma_f32 v[66:67], v[66:67], v[38:39], v[74:75] op_sel:[1,1,0] op_sel_hi:[1,0,1] neg_lo:[1,0,0]
    v_cvt_pk_bf16_f32 v80, v64, -v65
    v_cvt_pk_bf16_f32 v81, v66, -v67
    ds_write_b64 v4, v[80:81] offset:2176
    v_lshlrev_b32 v76, 16, v80
    v_and_b32 v77, s15, v80
    v_pk_add_f32 v[76:77], v[64:65], v[76:77] neg_lo:[0,1] neg_hi:[1,1]
    v_cvt_pk_bf16_f32 v82, v76, v77
    v_lshlrev_b32 v78, 16, v81
    v_and_b32 v79, s15, v81
    v_pk_add_f32 v[78:79], v[66:67], v[78:79] neg_lo:[0,1] neg_hi:[1,1]
    v_cvt_pk_bf16_f32 v83, v78, v79
    ds_write_b64 v4, v[82:83] offset:10880
    v_pk_mul_f32 v[72:73], v[64:65], v[36:37] op_sel:[0,0] op_sel_hi:[0,1]
    v_pk_fma_f32 v[64:65], v[64:65], v[36:37], v[72:73] op_sel:[1,1,0] op_sel_hi:[1,0,1] neg_lo:[1,0,0]
    v_pk_mul_f32 v[74:75], v[66:67], v[38:39] op_sel:[0,0] op_sel_hi:[0,1]
    v_pk_fma_f32 v[66:67], v[66:67], v[38:39], v[74:75] op_sel:[1,1,0] op_sel_hi:[1,0,1] neg_lo:[1,0,0]
    v_cvt_pk_bf16_f32 v80, v64, -v65
    v_cvt_pk_bf16_f32 v81, v66, -v67
    ds_write_b64 v4, v[80:81] offset:2720
    v_lshlrev_b32 v76, 16, v80
    v_and_b32 v77, s15, v80
    v_pk_add_f32 v[76:77], v[64:65], v[76:77] neg_lo:[0,1] neg_hi:[1,1]
    v_cvt_pk_bf16_f32 v82, v76, v77
    v_lshlrev_b32 v78, 16, v81
    v_and_b32 v79, s15, v81
    v_pk_add_f32 v[78:79], v[66:67], v[78:79] neg_lo:[0,1] neg_hi:[1,1]
    v_cvt_pk_bf16_f32 v83, v78, v79
    ds_write_b64 v4, v[82:83] offset:11424
    v_pk_mul_f32 v[72:73], v[64:65], v[36:37] op_sel:[0,0] op_sel_hi:[0,1]
    v_pk_fma_f32 v[64:65], v[64:65], v[36:37], v[72:73] op_sel:[1,1,0] op_sel_hi:[1,0,1] neg_lo:[1,0,0]
    v_pk_mul_f32 v[74:75], v[66:67], v[38:39] op_sel:[0,0] op_sel_hi:[0,1]
    v_pk_fma_f32 v[66:67], v[66:67], v[38:39], v[74:75] op_sel:[1,1,0] op_sel_hi:[1,0,1] neg_lo:[1,0,0]
    v_cvt_pk_bf16_f32 v80, v64, -v65
    v_cvt_pk_bf16_f32 v81, v66, -v67
    ds_write_b64 v4, v[80:81] offset:3264
    v_lshlrev_b32 v76, 16, v80
    v_and_b32 v77, s15, v80
    v_pk_add_f32 v[76:77], v[64:65], v[76:77] neg_lo:[0,1] neg_hi:[1,1]
    v_cvt_pk_bf16_f32 v82, v76, v77
    v_lshlrev_b32 v78, 16, v81
    v_and_b32 v79, s15, v81
    v_pk_add_f32 v[78:79], v[66:67], v[78:79] neg_lo:[0,1] neg_hi:[1,1]
    v_cvt_pk_bf16_f32 v83, v78, v79
    ds_write_b64 v4, v[82:83] offset:11968
    v_pk_mul_f32 v[72:73], v[64:65], v[36:37] op_sel:[0,0] op_sel_hi:[0,1]
    v_pk_fma_f32 v[64:65], v[64:65], v[36:37], v[72:73] op_sel:[1,1,0] op_sel_hi:[1,0,1] neg_lo:[1,0,0]
    v_pk_mul_f32 v[74:75], v[66:67], v[38:39] op_sel:[0,0] op_sel_hi:[0,1]
    v_pk_fma_f32 v[66:67], v[66:67], v[38:39], v[74:75] op_sel:[1,1,0] op_sel_hi:[1,0,1] neg_lo:[1,0,0]
    v_cvt_pk_bf16_f32 v80, v64, -v65
    v_cvt_pk_bf16_f32 v81, v66, -v67
    ds_write_b64 v4, v[80:81] offset:3808
    v_lshlrev_b32 v76, 16, v80
    v_and_b32 v77, s15, v80
    v_pk_add_f32 v[76:77], v[64:65], v[76:77] neg_lo:[0,1] neg_hi:[1,1]
    v_cvt_pk_bf16_f32 v82, v76, v77
    v_lshlrev_b32 v78, 16, v81
    v_and_b32 v79, s15, v81
    v_pk_add_f32 v[78:79], v[66:67], v[78:79] neg_lo:[0,1] neg_hi:[1,1]
    v_cvt_pk_bf16_f32 v83, v78, v79
    ds_write_b64 v4, v[82:83] offset:12512
    v_pk_mul_f32 v[72:73], v[64:65], v[36:37] op_sel:[0,0] op_sel_hi:[0,1]
    v_pk_fma_f32 v[64:65], v[64:65], v[36:37], v[72:73] op_sel:[1,1,0] op_sel_hi:[1,0,1] neg_lo:[1,0,0]
    v_pk_mul_f32 v[74:75], v[66:67], v[38:39] op_sel:[0,0] op_sel_hi:[0,1]
    v_pk_fma_f32 v[66:67], v[66:67], v[38:39], v[74:75] op_sel:[1,1,0] op_sel_hi:[1,0,1] neg_lo:[1,0,0]
    v_cvt_pk_bf16_f32 v80, v64, -v65
    v_cvt_pk_bf16_f32 v81, v66, -v67
    ds_write_b64 v4, v[80:81] offset:4352
    v_lshlrev_b32 v76, 16, v80
    v_and_b32 v77, s15, v80
    v_pk_add_f32 v[76:77], v[64:65], v[76:77] neg_lo:[0,1] neg_hi:[1,1]
    v_cvt_pk_bf16_f32 v82, v76, v77
    v_lshlrev_b32 v78, 16, v81
    v_and_b32 v79, s15, v81
    v_pk_add_f32 v[78:79], v[66:67], v[78:79] neg_lo:[0,1] neg_hi:[1,1]
    v_cvt_pk_bf16_f32 v83, v78, v79
    ds_write_b64 v4, v[82:83] offset:13056
    ds_read_b128 v[160:163], v7 offset:0
    ds_read_b128 v[164:167], v7 offset:8704
    ds_read_b128 v[168:171], v7 offset:64
    ds_read_b128 v[172:175], v7 offset:8768
    ds_read_b128 v[176:179], v7 offset:128
    ds_read_b128 v[180:183], v7 offset:8832
    ds_read_b128 v[184:187], v7 offset:192
    ds_read_b128 v[188:191], v7 offset:8896
    ds_read_b128 v[192:195], v7 offset:256
    ds_read_b128 v[196:199], v7 offset:8960
    ds_read_b128 v[200:203], v7 offset:320
    ds_read_b128 v[204:207], v7 offset:9024
    ds_read_b128 v[208:211], v7 offset:384
    ds_read_b128 v[212:215], v7 offset:9088
    ds_read_b128 v[216:219], v7 offset:448
    ds_read_b128 v[220:223], v7 offset:9152
    s_waitcnt lgkmcnt(14)
    v_mfma_f32_16x16x32_bf16 v[232:235], v[160:163], v[96:99], 0
    v_mfma_f32_16x16x32_bf16 v[232:235], v[160:163], v[100:103], v[232:235]
    v_mfma_f32_16x16x32_bf16 v[232:235], v[164:167], v[96:99], v[232:235]
    s_waitcnt lgkmcnt(12)
    v_mfma_f32_16x16x32_bf16 v[232:235], v[168:171], v[104:107], v[232:235]
    v_mfma_f32_16x16x32_bf16 v[232:235], v[168:171], v[108:111], v[232:235]
    v_mfma_f32_16x16x32_bf16 v[232:235], v[172:175], v[104:107], v[232:235]
    s_waitcnt lgkmcnt(10)
    v_mfma_f32_16x16x32_bf16 v[232:235], v[176:179], v[112:115], v[232:235]
    v_mfma_f32_16x16x32_bf16 v[232:235], v[176:179], v[116:119], v[232:235]
    v_mfma_f32_16x16x32_bf16 v[232:235], v[180:183], v[112:115], v[232:235]
    s_waitcnt lgkmcnt(8)
    v_mfma_f32_16x16x32_bf16 v[232:235], v[184:187], v[120:123], v[232:235]
    v_mfma_f32_16x16x32_bf16 v[232:235], v[184:187], v[124:127], v[232:235]
    v_mfma_f32_16x16x32_bf16 v[232:235], v[188:191], v[120:123], v[232:235]
    s_waitcnt lgkmcnt(6)
    v_mfma_f32_16x16x32_bf16 v[232:235], v[192:195], v[128:131], v[232:235]
    v_mfma_f32_16x16x32_bf16 v[232:235], v[192:195], v[132:135], v[232:235]
    v_mfma_f32_16x16x32_bf16 v[232:235], v[196:199], v[128:131], v[232:235]
    s_waitcnt lgkmcnt(4)
    v_mfma_f32_16x16x32_bf16 v[232:235], v[200:203], v[136:139], v[232:235]
    v_mfma_f32_16x16x32_bf16 v[232:235], v[200:203], v[140:143], v[232:235]
    v_mfma_f32_16x16x32_bf16 v[232:235], v[204:207], v[136:139], v[232:235]
    s_waitcnt lgkmcnt(2)
    v_mfma_f32_16x16x32_bf16 v[232:235], v[208:211], v[144:147], v[232:235]
    v_mfma_f32_16x16x32_bf16 v[232:235], v[208:211], v[148:151], v[232:235]
    v_mfma_f32_16x16x32_bf16 v[232:235], v[212:215], v[144:147], v[232:235]
    s_waitcnt lgkmcnt(0)
    v_mfma_f32_16x16x32_bf16 v[232:235], v[216:219], v[152:155], v[232:235]
    v_mfma_f32_16x16x32_bf16 v[232:235], v[216:219], v[156:159], v[232:235]
    v_mfma_f32_16x16x32_bf16 v[232:235], v[220:223], v[152:155], v[232:235]
    v_lshlrev_b32 v8, 5, v5
    v_add_u32 v8, s11, v8
    v_lshlrev_b32 v10, 9, v6
    v_add_u32 v10, 1024, v10
    v_lshlrev_b32 v11, 4, v6
    v_add_u32 v11, 2016, v11
    v_mov_b32 v12, 8
    v_mov_b32 v13, 512
    v_cmp_gt_u32 vcc, 2, v6
    s_nop 1
    v_cndmask_b32 v10, v11, v10, vcc
    v_cndmask_b32 v12, v13, v12, vcc
    v_add_u32 v10, v8, v10
    v_add_u32 v11, v10, v12
    v_add_u32 v13, v11, v12
    v_add_u32 v14, v13, v12
    v_lshlrev_b32 v15, 11, v6
    v_add_u32 v15, 4096, v15
    v_add_u32 v15, v8, v15
    ds_write_b32 v10, v228
    ds_write_b32 v11, v229
    ds_write_b32 v13, v230
    ds_write_b32 v14, v231
    ds_write_b32 v15, v232 offset:0
    ds_write_b32 v15, v233 offset:512
    ds_write_b32 v15, v234 offset:1024
    ds_write_b32 v15, v235 offset:1536
K1_EXP:
    v_lshrrev_b32 v8, 8, v0
    v_and_b32 v9, 255, v0
    v_mul_u32_u24 v10, 69632, v8
    v_add_u32 v14, 17408, v10
    v_lshlrev_b32 v11, 1, v9
    v_xor_b32 v11, 63, v11
    v_cmp_gt_u32 vcc, 128, v9
    s_nop 1
    v_cndmask_b32 v15, v14, v10, vcc
    v_add_u32 v12, 0, v11
    v_add_u32 v13, -1, v11
    v_cvt_f32_u32 v12, v12
    v_cvt_f32_u32 v13, v13
    v_cvt_pk_bf16_f32 v12, v12, v13
    v_lshlrev_b32 v13, 16, v12
    v_and_b32 v12, s15, v12
    v_cvt_u32_f32 v13, v13
    v_cvt_u32_f32 v12, v12
    v_lshl_add_u32 v20, v13, 2, v15
    v_lshl_add_u32 v21, v12, 2, v15
    v_add_u32 v12, 512, v11
    v_add_u32 v13, 511, v11
    v_cvt_f32_u32 v12, v12
    v_cvt_f32_u32 v13, v13
    v_cvt_pk_bf16_f32 v12, v12, v13
    v_lshlrev_b32 v13, 16, v12
    v_and_b32 v12, s15, v12
    v_cvt_u32_f32 v13, v13
    v_cvt_u32_f32 v12, v12
    v_lshl_add_u32 v22, v13, 2, v14
    v_lshl_add_u32 v23, v12, 2, v14
    v_add_u32 v12, 1024, v11
    v_add_u32 v13, 1023, v11
    v_cvt_f32_u32 v12, v12
    v_cvt_f32_u32 v13, v13
    v_cvt_pk_bf16_f32 v12, v12, v13
    v_lshlrev_b32 v13, 16, v12
    v_and_b32 v12, s15, v12
    v_cvt_u32_f32 v13, v13
    v_cvt_u32_f32 v12, v12
    v_lshl_add_u32 v24, v13, 2, v14
    v_lshl_add_u32 v25, v12, 2, v14
    v_add_u32 v12, 1536, v11
    v_add_u32 v13, 1535, v11
    v_cvt_f32_u32 v12, v12
    v_cvt_f32_u32 v13, v13
    v_cvt_pk_bf16_f32 v12, v12, v13
    v_lshlrev_b32 v13, 16, v12
    v_and_b32 v12, s15, v12
    v_cvt_u32_f32 v13, v13
    v_cvt_u32_f32 v12, v12
    v_lshl_add_u32 v26, v13, 2, v14
    v_lshl_add_u32 v27, v12, 2, v14
    v_lshrrev_b32 v12, 5, v9
    v_mul_u32_u24 v12, 160, v12
    v_and_b32 v13, 31, v9
    v_lshl_add_u32 v12, v13, 2, v12
    v_mul_u32_u24 v13, 7552, v8
    v_add_u32 v12, v12, v13
    v_add_u32 v12, 141664, v12
    s_waitcnt lgkmcnt(0)
    s_barrier
    ds_read_b32 v40, v20
    ds_read_b32 v56, v20 offset:34816
    ds_read_b32 v41, v21
    ds_read_b32 v57, v21 offset:34816
    ds_read_b32 v42, v22
    ds_read_b32 v58, v22 offset:34816
    ds_read_b32 v43, v23
    ds_read_b32 v59, v23 offset:34816
    ds_read_b32 v44, v24
    ds_read_b32 v60, v24 offset:34816
    ds_read_b32 v45, v25
    ds_read_b32 v61, v25 offset:34816
    ds_read_b32 v46, v26
    ds_read_b32 v62, v26 offset:34816
    s_waitcnt lgkmcnt(0)
    ds_read_b32 v47, v27
    ds_read_b32 v63, v27 offset:34816
    s_waitcnt lgkmcnt(0)
    v_add_f32 v40, v40, v56
    v_add_f32 v41, v41, v57
    v_cvt_pk_bf16_f32 v72, v40, v41
    ds_write_b32 v12, v72 offset:0
    v_add_f32 v42, v42, v58
    v_add_f32 v43, v43, v59
    v_cvt_pk_bf16_f32 v73, v42, v43
    ds_write_b32 v12, v73 offset:1280
    v_add_f32 v44, v44, v60
    v_add_f32 v45, v45, v61
    v_cvt_pk_bf16_f32 v74, v44, v45
    ds_write_b32 v12, v74 offset:2560
    v_add_f32 v46, v46, v62
    v_add_f32 v47, v47, v63
    v_cvt_pk_bf16_f32 v75, v46, v47
    ds_write_b32 v12, v75 offset:3840
    s_cmp_eq_u32 s56, 0
    s_cbranch_scc1 K1_NOSJ
    s_cmp_ge_u32 s58, 196
    s_cbranch_scc1 K1_WDONE1
    v_lshrrev_b32 v236, 2, v5
    v_and_b32 v237, 1, v5
    v_lshlrev_b32 v237, 4, v237
    v_mov_b32 v238, 0x3f80
    v_lshlrev_b32 v237, v237, v238
    v_cmp_eq_u32 vcc, v236, v6
    s_nop 1
    v_cndmask_b32 v237, 0, v237, vcc
    v_bfe_u32 v238, v5, 1, 1
    v_cmp_eq_u32 vcc, 0, v238
    s_nop 1
    v_cndmask_b32 v160, 0, v237, vcc
    v_cndmask_b32 v161, v237, 0, vcc
    v_mov_b32 v162, 0
    v_mov_b32 v163, 0
    v_mov_b32 v164, 0
    v_mov_b32 v165, 0
    v_mov_b32 v166, v160
    v_mov_b32 v167, v161
    v_lshlrev_b32 v236, 4, v2
    v_add_u32 v236, s55, v236
    v_add_u32 v237, s50, v236
    s_waitcnt vmcnt(0)
    v_mfma_f32_16x16x32_bf16 v[168:171], v[240:243], v[160:163], 0
    v_mfma_f32_16x16x32_bf16 v[172:175], v[244:247], v[160:163], 0
    v_mfma_f32_16x16x32_bf16 v[176:179], v[240:243], v[164:167], 0
    v_mfma_f32_16x16x32_bf16 v[180:183], v[244:247], v[164:167], 0
    s_nop 4
    v_cvt_pk_bf16_f32 v184, v168, v169
    v_cvt_pk_bf16_f32 v185, v170, v171
    v_cvt_pk_bf16_f32 v186, v172, v173
    v_cvt_pk_bf16_f32 v187, v174, v175
    global_store_dwordx4 v236, v[184:187], s[32:33] sc1
    v_cvt_pk_bf16_f32 v188, v176, v177
    v_cvt_pk_bf16_f32 v189, v178, v179
    v_cvt_pk_bf16_f32 v190, v180, v181
    v_cvt_pk_bf16_f32 v191, v182, v183
    global_store_dwordx4 v237, v[188:191], s[32:33] sc1
K1_WDONE1:
    s_nop 1
K1_NOSJ:
    v_lshlrev_b32 v5, 5, v0
    v_add_u32 v5, 2097152, v5
    s_cmp_lg_u32 s3, 0
    s_cbranch_scc1 K1_POLLED
    v_mov_b32 v10, 0
    s_mov_b32 s6, 0
K1_POLL:
    global_load_dword v11, v10, s[34:35] offset:128 sc1
    s_waitcnt vmcnt(0)
    v_readfirstlane_b32 s7, v11
    s_cmp_eq_u32 s7, 1
    s_cbranch_scc1 K1_POLLED
    s_sleep 2
    s_add_u32 s6, s6, 1
    s_cmp_lt_u32 s6, 0x100000
    s_cbranch_scc1 K1_POLL
K1_POLLED:
    s_waitcnt lgkmcnt(0)
    s_barrier
    global_load_dwordx4 v[24:27], v5, s[32:33] sc1
    global_load_dwordx4 v[28:31], v5, s[32:33] offset:16 sc1
    v_mov_b32 v40, 0
    v_mov_b32 v41, 0
    v_mov_b32 v42, 0
    v_mov_b32 v43, 0
    v_lshlrev_b32 v6, 3, v0
    v_lshlrev_b32 v7, 4, v0
    v_cmp_gt_u32 vcc, 8, v0
    s_and_saveexec_b64 s[12:13], vcc
    ds_write_b128 v7, v[40:43]
    ds_write_b128 v7, v[40:43] offset:4288
    ds_write_b128 v7, v[40:43] offset:8704
    ds_write_b128 v7, v[40:43] offset:12992
    s_mov_b64 exec, s[12:13]
    s_mul_i32 s6, s4, 8704
    s_and_b32 s5, s3, 3
    v_and_b32 v16, 15, v2
    v_lshrrev_b32 v17, 4, v2
    v_lshl_add_u32 v18, v17, 3, v16
    v_add_u32 v18, 1, v18
    v_and_b32 v19, 1, v18
    v_mul_u32_u24 v19, 4288, v19
    v_lshrrev_b32 v18, 1, v18
    v_lshl_add_u32 v18, v18, 2, v19
    v_add_u32 v56, s6, v18
    v_add_u32 v57, 1024, v56
    v_add_u32 v58, 2048, v56
    v_add_u32 v59, 3072, v56
    v_add_u32 v60, 4096, v56
    v_mul_u32_u24 v61, 160, v16
    v_lshl_add_u32 v61, v17, 4, v61
    s_mul_i32 s6, s4, 7552
    s_add_u32 s6, s6, 139264
    v_add_u32 v61, s6, v61
    v_mul_u32_u24 v62, 272, v16
    v_lshl_add_u32 v62, v17, 4, v62
    s_mul_i32 s6, s3, 8704
    s_add_u32 s6, s6, 17408
    v_add_u32 v62, s6, v62
    s_lshl_b32 s12, s59, 16
    s_and_b32 s13, s59, s15
    s_waitcnt vmcnt(0)
    v_lshlrev_b32 v40, 16, v248
    v_sub_f32 v40, v40, v24
    v_lshlrev_b32 v41, 16, v249
    v_sub_f32 v41, v41, v26
    v_cvt_pk_bf16_f32 v40, v40, v41
    v_lshlrev_b32 v41, 16, v40
    v_and_b32 v42, s15, v40
    v_mul_f32 v41, v41, v25
    v_mul_f32 v42, v42, v27
    v_cvt_pk_bf16_f32 v44, v41, v42
    v_lshlrev_b32 v40, 16, v250
    v_sub_f32 v40, v40, v28
    v_lshlrev_b32 v41, 16, v251
    v_sub_f32 v41, v41, v30
    v_cvt_pk_bf16_f32 v40, v40, v41
    v_lshlrev_b32 v41, 16, v40
    v_and_b32 v42, s15, v40
    v_mul_f32 v41, v41, v29
    v_mul_f32 v42, v42, v31
    v_cvt_pk_bf16_f32 v45, v41, v42
    ds_write_b64 v6, v[44:45] offset:128
    v_alignbit_b32 v52, v45, v44, 16
    ds_write_b32 v6, v52 offset:4416
    ds_write_b16_d16_hi v6, v45 offset:4420
    ds_write_b16 v6, v44 offset:4414
    v_and_b32 v40, s15, v248
    v_sub_f32 v40, v40, v24
    v_and_b32 v41, s15, v249
    v_sub_f32 v41, v41, v26
    v_cvt_pk_bf16_f32 v40, v40, v41
    v_lshlrev_b32 v41, 16, v40
    v_and_b32 v42, s15, v40
    v_mul_f32 v41, v41, v25
    v_mul_f32 v42, v42, v27
    v_cvt_pk_bf16_f32 v46, v41, v42
    v_and_b32 v40, s15, v250
    v_sub_f32 v40, v40, v28
    v_and_b32 v41, s15, v251
    v_sub_f32 v41, v41, v30
    v_cvt_pk_bf16_f32 v40, v40, v41
    v_lshlrev_b32 v41, 16, v40
    v_and_b32 v42, s15, v40
    v_mul_f32 v41, v41, v29
    v_mul_f32 v42, v42, v31
    v_cvt_pk_bf16_f32 v47, v41, v42
    ds_write_b64 v6, v[46:47] offset:8832
    v_alignbit_b32 v52, v47, v46, 16
    ds_write_b32 v6, v52 offset:13120
    ds_write_b16_d16_hi v6, v47 offset:13124
    ds_write_b16 v6, v46 offset:13118
    s_waitcnt lgkmcnt(0)
    s_barrier
    s_cmp_eq_u32 s5, 1
    s_cbranch_scc1 K2_Q1
    s_cmp_eq_u32 s5, 2
    s_cbranch_scc1 K2_Q2
    s_cmp_eq_u32 s5, 3
    s_cbranch_scc1 K2_Q3
    ds_read2_b32 v[64:65], v56 offset0:0 offset1:1
    ds_read2_b32 v[66:67], v56 offset0:2 offset1:3
    ds_read2_b32 v[68:69], v56 offset0:8 offset1:9
    ds_read2_b32 v[70:71], v56 offset0:10 offset1:11
    ds_read2_b32 v[72:73], v56 offset0:16 offset1:17
    ds_read2_b32 v[74:75], v56 offset0:18 offset1:19
    ds_read2_b32 v[76:77], v56 offset0:24 offset1:25
    ds_read2_b32 v[78:79], v56 offset0:26 offset1:27
    ds_read2_b32 v[80:81], v56 offset0:32 offset1:33
    ds_read2_b32 v[82:83], v56 offset0:34 offset1:35
    ds_read2_b32 v[84:85], v56 offset0:40 offset1:41
    ds_read2_b32 v[86:87], v56 offset0:42 offset1:43
    ds_read_b128 v[104:107], v61 offset:2400
    ds_read_b128 v[108:111], v61 offset:4960
    ds_read_b128 v[112:115], v61 offset:2464
    ds_read_b128 v[116:119], v61 offset:5024
    s_waitcnt lgkmcnt(0)
    v_mfma_f32_16x16x32_bf16 v[136:139], v[64:67], v[104:107], 0
    ds_read_b128 v[120:123], v61 offset:2240
    v_mfma_f32_16x16x32_bf16 v[144:147], v[68:71], v[104:107], 0
    ds_read_b128 v[124:127], v61 offset:4800
    v_mfma_f32_16x16x32_bf16 v[152:155], v[72:75], v[104:107], 0
    ds_read_b128 v[128:131], v61 offset:2304
    v_mfma_f32_16x16x32_bf16 v[160:163], v[76:79], v[104:107], 0
    ds_read_b128 v[132:135], v61 offset:4864
    v_mfma_f32_16x16x32_bf16 v[140:143], v[64:67], v[108:111], 0
    ds_read2_b32 v[88:89], v56 offset0:48 offset1:49
    v_mfma_f32_16x16x32_bf16 v[148:151], v[68:71], v[108:111], 0
    ds_read2_b32 v[90:91], v56 offset0:50 offset1:51
    v_mfma_f32_16x16x32_bf16 v[156:159], v[72:75], v[108:111], 0
    ds_read2_b32 v[92:93], v56 offset0:56 offset1:57
    v_mfma_f32_16x16x32_bf16 v[164:167], v[76:79], v[108:111], 0
    ds_read2_b32 v[94:95], v56 offset0:58 offset1:59
    v_mfma_f32_16x16x32_bf16 v[136:139], v[72:75], v[112:115], v[136:139]
    ds_read2_b32 v[96:97], v56 offset0:64 offset1:65
    v_mfma_f32_16x16x32_bf16 v[144:147], v[76:79], v[112:115], v[144:147]
    ds_read2_b32 v[98:99], v56 offset0:66 offset1:67
    v_mfma_f32_16x16x32_bf16 v[152:155], v[80:83], v[112:115], v[152:155]
    ds_read2_b32 v[100:101], v56 offset0:72 offset1:73
    v_mfma_f32_16x16x32_bf16 v[160:163], v[84:87], v[112:115], v[160:163]
    ds_read2_b32 v[102:103], v56 offset0:74 offset1:75
    v_mfma_f32_16x16x32_bf16 v[140:143], v[72:75], v[116:119], v[140:143]
    v_mfma_f32_16x16x32_bf16 v[148:151], v[76:79], v[116:119], v[148:151]
    v_mfma_f32_16x16x32_bf16 v[156:159], v[80:83], v[116:119], v[156:159]
    v_mfma_f32_16x16x32_bf16 v[164:167], v[84:87], v[116:119], v[164:167]
    s_waitcnt lgkmcnt(0)
    v_mfma_f32_16x16x32_bf16 v[136:139], v[80:83], v[120:123], v[136:139]
    ds_read_b128 v[104:107], v61 offset:2080
    v_mfma_f32_16x16x32_bf16 v[144:147], v[84:87], v[120:123], v[144:147]
    ds_read_b128 v[108:111], v61 offset:4640
    v_mfma_f32_16x16x32_bf16 v[152:155], v[88:91], v[120:123], v[152:155]
    ds_read_b128 v[112:115], v61 offset:2144
    v_mfma_f32_16x16x32_bf16 v[160:163], v[92:95], v[120:123], v[160:163]
    ds_read_b128 v[116:119], v61 offset:4704
    v_mfma_f32_16x16x32_bf16 v[140:143], v[80:83], v[124:127], v[140:143]
    ds_read2_b32 v[64:65], v56 offset0:80 offset1:81
    v_mfma_f32_16x16x32_bf16 v[148:151], v[84:87], v[124:127], v[148:151]
    ds_read2_b32 v[66:67], v56 offset0:82 offset1:83
    v_mfma_f32_16x16x32_bf16 v[156:159], v[88:91], v[124:127], v[156:159]
    ds_read2_b32 v[68:69], v56 offset0:88 offset1:89
    v_mfma_f32_16x16x32_bf16 v[164:167], v[92:95], v[124:127], v[164:167]
    ds_read2_b32 v[70:71], v56 offset0:90 offset1:91
    v_mfma_f32_16x16x32_bf16 v[136:139], v[88:91], v[128:131], v[136:139]
    ds_read2_b32 v[72:73], v56 offset0:96 offset1:97
    v_mfma_f32_16x16x32_bf16 v[144:147], v[92:95], v[128:131], v[144:147]
    ds_read2_b32 v[74:75], v56 offset0:98 offset1:99
    v_mfma_f32_16x16x32_bf16 v[152:155], v[96:99], v[128:131], v[152:155]
    ds_read2_b32 v[76:77], v56 offset0:104 offset1:105
    v_mfma_f32_16x16x32_bf16 v[160:163], v[100:103], v[128:131], v[160:163]
    ds_read2_b32 v[78:79], v56 offset0:106 offset1:107
    v_mfma_f32_16x16x32_bf16 v[140:143], v[88:91], v[132:135], v[140:143]
    v_mfma_f32_16x16x32_bf16 v[148:151], v[92:95], v[132:135], v[148:151]
    v_mfma_f32_16x16x32_bf16 v[156:159], v[96:99], v[132:135], v[156:159]
    v_mfma_f32_16x16x32_bf16 v[164:167], v[100:103], v[132:135], v[164:167]
    s_waitcnt lgkmcnt(0)
    v_mfma_f32_16x16x32_bf16 v[136:139], v[96:99], v[104:107], v[136:139]
    ds_read_b128 v[120:123], v61 offset:1920
    v_mfma_f32_16x16x32_bf16 v[144:147], v[100:103], v[104:107], v[144:147]
    ds_read_b128 v[124:127], v61 offset:4480
    v_mfma_f32_16x16x32_bf16 v[152:155], v[64:67], v[104:107], v[152:155]
    ds_read_b128 v[128:131], v61 offset:1984
    v_mfma_f32_16x16x32_bf16 v[160:163], v[68:71], v[104:107], v[160:163]
    ds_read_b128 v[132:135], v61 offset:4544
    v_mfma_f32_16x16x32_bf16 v[140:143], v[96:99], v[108:111], v[140:143]
    ds_read2_b32 v[80:81], v56 offset0:112 offset1:113
    v_mfma_f32_16x16x32_bf16 v[148:151], v[100:103], v[108:111], v[148:151]
    ds_read2_b32 v[82:83], v56 offset0:114 offset1:115
    v_mfma_f32_16x16x32_bf16 v[156:159], v[64:67], v[108:111], v[156:159]
    ds_read2_b32 v[84:85], v56 offset0:120 offset1:121
    v_mfma_f32_16x16x32_bf16 v[164:167], v[68:71], v[108:111], v[164:167]
    ds_read2_b32 v[86:87], v56 offset0:122 offset1:123
    v_mfma_f32_16x16x32_bf16 v[136:139], v[64:67], v[112:115], v[136:139]
    ds_read2_b32 v[88:89], v56 offset0:128 offset1:129
    v_mfma_f32_16x16x32_bf16 v[144:147], v[68:71], v[112:115], v[144:147]
    ds_read2_b32 v[90:91], v56 offset0:130 offset1:131
    v_mfma_f32_16x16x32_bf16 v[152:155], v[72:75], v[112:115], v[152:155]
    ds_read2_b32 v[92:93], v56 offset0:136 offset1:137
    v_mfma_f32_16x16x32_bf16 v[160:163], v[76:79], v[112:115], v[160:163]
    ds_read2_b32 v[94:95], v56 offset0:138 offset1:139
    v_mfma_f32_16x16x32_bf16 v[140:143], v[64:67], v[116:119], v[140:143]
    v_mfma_f32_16x16x32_bf16 v[148:151], v[68:71], v[116:119], v[148:151]
    v_mfma_f32_16x16x32_bf16 v[156:159], v[72:75], v[116:119], v[156:159]
    v_mfma_f32_16x16x32_bf16 v[164:167], v[76:79], v[116:119], v[164:167]
    s_waitcnt lgkmcnt(0)
    v_mfma_f32_16x16x32_bf16 v[136:139], v[72:75], v[120:123], v[136:139]
    ds_read_b128 v[104:107], v61 offset:1760
    v_mfma_f32_16x16x32_bf16 v[144:147], v[76:79], v[120:123], v[144:147]
    ds_read_b128 v[108:111], v61 offset:4320
    v_mfma_f32_16x16x32_bf16 v[152:155], v[80:83], v[120:123], v[152:155]
    ds_read_b128 v[112:115], v61 offset:1824
    v_mfma_f32_16x16x32_bf16 v[160:163], v[84:87], v[120:123], v[160:163]
    ds_read_b128 v[116:119], v61 offset:4384
    v_mfma_f32_16x16x32_bf16 v[140:143], v[72:75], v[124:127], v[140:143]
    ds_read2_b32 v[96:97], v56 offset0:144 offset1:145
    v_mfma_f32_16x16x32_bf16 v[148:151], v[76:79], v[124:127], v[148:151]
    ds_read2_b32 v[98:99], v56 offset0:146 offset1:147
    v_mfma_f32_16x16x32_bf16 v[156:159], v[80:83], v[124:127], v[156:159]
    ds_read2_b32 v[100:101], v56 offset0:152 offset1:153
    v_mfma_f32_16x16x32_bf16 v[164:167], v[84:87], v[124:127], v[164:167]
    ds_read2_b32 v[102:103], v56 offset0:154 offset1:155
    v_mfma_f32_16x16x32_bf16 v[136:139], v[80:83], v[128:131], v[136:139]
    ds_read2_b32 v[64:65], v56 offset0:160 offset1:161
    v_mfma_f32_16x16x32_bf16 v[144:147], v[84:87], v[128:131], v[144:147]
    ds_read2_b32 v[66:67], v56 offset0:162 offset1:163
    v_mfma_f32_16x16x32_bf16 v[152:155], v[88:91], v[128:131], v[152:155]
    ds_read2_b32 v[68:69], v56 offset0:168 offset1:169
    v_mfma_f32_16x16x32_bf16 v[160:163], v[92:95], v[128:131], v[160:163]
    ds_read2_b32 v[70:71], v56 offset0:170 offset1:171
    v_mfma_f32_16x16x32_bf16 v[140:143], v[80:83], v[132:135], v[140:143]
    v_mfma_f32_16x16x32_bf16 v[148:151], v[84:87], v[132:135], v[148:151]
    v_mfma_f32_16x16x32_bf16 v[156:159], v[88:91], v[132:135], v[156:159]
    v_mfma_f32_16x16x32_bf16 v[164:167], v[92:95], v[132:135], v[164:167]
    s_waitcnt lgkmcnt(0)
    v_mfma_f32_16x16x32_bf16 v[136:139], v[88:91], v[104:107], v[136:139]
    ds_read_b128 v[120:123], v61 offset:1600
    v_mfma_f32_16x16x32_bf16 v[144:147], v[92:95], v[104:107], v[144:147]
    ds_read_b128 v[124:127], v61 offset:4160
    v_mfma_f32_16x16x32_bf16 v[152:155], v[96:99], v[104:107], v[152:155]
    ds_read_b128 v[128:131], v61 offset:1664
    v_mfma_f32_16x16x32_bf16 v[160:163], v[100:103], v[104:107], v[160:163]
    ds_read_b128 v[132:135], v61 offset:4224
    v_mfma_f32_16x16x32_bf16 v[140:143], v[88:91], v[108:111], v[140:143]
    ds_read2_b32 v[72:73], v56 offset0:176 offset1:177
    v_mfma_f32_16x16x32_bf16 v[148:151], v[92:95], v[108:111], v[148:151]
    ds_read2_b32 v[74:75], v56 offset0:178 offset1:179
    v_mfma_f32_16x16x32_bf16 v[156:159], v[96:99], v[108:111], v[156:159]
    ds_read2_b32 v[76:77], v56 offset0:184 offset1:185
    v_mfma_f32_16x16x32_bf16 v[164:167], v[100:103], v[108:111], v[164:167]
    ds_read2_b32 v[78:79], v56 offset0:186 offset1:187
    v_mfma_f32_16x16x32_bf16 v[136:139], v[96:99], v[112:115], v[136:139]
    ds_read2_b32 v[80:81], v56 offset0:192 offset1:193
    v_mfma_f32_16x16x32_bf16 v[144:147], v[100:103], v[112:115], v[144:147]
    ds_read2_b32 v[82:83], v56 offset0:194 offset1:195
    v_mfma_f32_16x16x32_bf16 v[152:155], v[64:67], v[112:115], v[152:155]
    ds_read2_b32 v[84:85], v56 offset0:200 offset1:201
    v_mfma_f32_16x16x32_bf16 v[160:163], v[68:71], v[112:115], v[160:163]
    ds_read2_b32 v[86:87], v56 offset0:202 offset1:203
    v_mfma_f32_16x16x32_bf16 v[140:143], v[96:99], v[116:119], v[140:143]
    v_mfma_f32_16x16x32_bf16 v[148:151], v[100:103], v[116:119], v[148:151]
    v_mfma_f32_16x16x32_bf16 v[156:159], v[64:67], v[116:119], v[156:159]
    v_mfma_f32_16x16x32_bf16 v[164:167], v[68:71], v[116:119], v[164:167]
    s_waitcnt lgkmcnt(0)
    v_mfma_f32_16x16x32_bf16 v[136:139], v[64:67], v[120:123], v[136:139]
    v_mfma_f32_16x16x32_bf16 v[144:147], v[68:71], v[120:123], v[144:147]
    v_mfma_f32_16x16x32_bf16 v[152:155], v[72:75], v[120:123], v[152:155]
    v_mfma_f32_16x16x32_bf16 v[160:163], v[76:79], v[120:123], v[160:163]
    v_mfma_f32_16x16x32_bf16 v[140:143], v[64:67], v[124:127], v[140:143]
    v_mfma_f32_16x16x32_bf16 v[148:151], v[68:71], v[124:127], v[148:151]
    v_mfma_f32_16x16x32_bf16 v[156:159], v[72:75], v[124:127], v[156:159]
    v_mfma_f32_16x16x32_bf16 v[164:167], v[76:79], v[124:127], v[164:167]
    v_mfma_f32_16x16x32_bf16 v[136:139], v[72:75], v[128:131], v[136:139]
    v_mfma_f32_16x16x32_bf16 v[144:147], v[76:79], v[128:131], v[144:147]
    v_mfma_f32_16x16x32_bf16 v[152:155], v[80:83], v[128:131], v[152:155]
    v_mfma_f32_16x16x32_bf16 v[160:163], v[84:87], v[128:131], v[160:163]
    v_mfma_f32_16x16x32_bf16 v[140:143], v[72:75], v[132:135], v[140:143]
    v_mfma_f32_16x16x32_bf16 v[148:151], v[76:79], v[132:135], v[148:151]
    v_mfma_f32_16x16x32_bf16 v[156:159], v[80:83], v[132:135], v[156:159]
    v_mfma_f32_16x16x32_bf16 v[164:167], v[84:87], v[132:135], v[164:167]
    s_branch K2_EPI
K2_Q1:
    ds_read2_b32 v[80:81], v56 offset0:192 offset1:193
    ds_read2_b32 v[82:83], v56 offset0:194 offset1:195
    ds_read2_b32 v[84:85], v56 offset0:200 offset1:201
    ds_read2_b32 v[86:87], v56 offset0:202 offset1:203
    ds_read2_b32 v[88:89], v56 offset0:208 offset1:209
    ds_read2_b32 v[90:91], v56 offset0:210 offset1:211
    ds_read2_b32 v[92:93], v56 offset0:216 offset1:217
    ds_read2_b32 v[94:95], v56 offset0:218 offset1:219
    ds_read2_b32 v[96:97], v56 offset0:224 offset1:225
    ds_read2_b32 v[98:99], v56 offset0:226 offset1:227
    ds_read2_b32 v[100:101], v56 offset0:232 offset1:233
    ds_read2_b32 v[102:103], v56 offset0:234 offset1:235
    ds_read_b128 v[104:107], v61 offset:1440
    ds_read_b128 v[108:111], v61 offset:4000
    ds_read_b128 v[112:115], v61 offset:1504
    ds_read_b128 v[116:119], v61 offset:4064
    s_waitcnt lgkmcnt(0)
    v_mfma_f32_16x16x32_bf16 v[136:139], v[80:83], v[104:107], 0
    ds_read_b128 v[120:123], v61 offset:1280
    v_mfma_f32_16x16x32_bf16 v[144:147], v[84:87], v[104:107], 0
    ds_read_b128 v[124:127], v61 offset:3840
    v_mfma_f32_16x16x32_bf16 v[152:155], v[88:91], v[104:107], 0
    ds_read_b128 v[128:131], v61 offset:1344
    v_mfma_f32_16x16x32_bf16 v[160:163], v[92:95], v[104:107], 0
    ds_read_b128 v[132:135], v61 offset:3904
    v_mfma_f32_16x16x32_bf16 v[140:143], v[80:83], v[108:111], 0
    ds_read2_b32 v[64:65], v56 offset0:240 offset1:241
    v_mfma_f32_16x16x32_bf16 v[148:151], v[84:87], v[108:111], 0
    ds_read2_b32 v[66:67], v56 offset0:242 offset1:243
    v_mfma_f32_16x16x32_bf16 v[156:159], v[88:91], v[108:111], 0
    ds_read2_b32 v[68:69], v56 offset0:248 offset1:249
    v_mfma_f32_16x16x32_bf16 v[164:167], v[92:95], v[108:111], 0
    ds_read2_b32 v[70:71], v56 offset0:250 offset1:251
    v_mfma_f32_16x16x32_bf16 v[136:139], v[88:91], v[112:115], v[136:139]
    ds_read2_b32 v[72:73], v57 offset0:0 offset1:1
    v_mfma_f32_16x16x32_bf16 v[144:147], v[92:95], v[112:115], v[144:147]
    ds_read2_b32 v[74:75], v57 offset0:2 offset1:3
    v_mfma_f32_16x16x32_bf16 v[152:155], v[96:99], v[112:115], v[152:155]
    ds_read2_b32 v[76:77], v57 offset0:8 offset1:9
    v_mfma_f32_16x16x32_bf16 v[160:163], v[100:103], v[112:115], v[160:163]
    ds_read2_b32 v[78:79], v57 offset0:10 offset1:11
    v_mfma_f32_16x16x32_bf16 v[140:143], v[88:91], v[116:119], v[140:143]
    v_mfma_f32_16x16x32_bf16 v[148:151], v[92:95], v[116:119], v[148:151]
    v_mfma_f32_16x16x32_bf16 v[156:159], v[96:99], v[116:119], v[156:159]
    v_mfma_f32_16x16x32_bf16 v[164:167], v[100:103], v[116:119], v[164:167]
    s_waitcnt lgkmcnt(0)
    v_mfma_f32_16x16x32_bf16 v[136:139], v[96:99], v[120:123], v[136:139]
    ds_read_b128 v[104:107], v61 offset:1120
    v_mfma_f32_16x16x32_bf16 v[144:147], v[100:103], v[120:123], v[144:147]
    ds_read_b128 v[108:111], v61 offset:3680
    v_mfma_f32_16x16x32_bf16 v[152:155], v[64:67], v[120:123], v[152:155]
    ds_read_b128 v[112:115], v61 offset:1184
    v_mfma_f32_16x16x32_bf16 v[160:163], v[68:71], v[120:123], v[160:163]
    ds_read_b128 v[116:119], v61 offset:3744
    v_mfma_f32_16x16x32_bf16 v[140:143], v[96:99], v[124:127], v[140:143]
    ds_read2_b32 v[80:81], v57 offset0:16 offset1:17
    v_mfma_f32_16x16x32_bf16 v[148:151], v[100:103], v[124:127], v[148:151]
    ds_read2_b32 v[82:83], v57 offset0:18 offset1:19
    v_mfma_f32_16x16x32_bf16 v[156:159], v[64:67], v[124:127], v[156:159]
    ds_read2_b32 v[84:85], v57 offset0:24 offset1:25
    v_mfma_f32_16x16x32_bf16 v[164:167], v[68:71], v[124:127], v[164:167]
    ds_read2_b32 v[86:87], v57 offset0:26 offset1:27
    v_mfma_f32_16x16x32_bf16 v[136:139], v[64:67], v[128:131], v[136:139]
    ds_read2_b32 v[88:89], v57 offset0:32 offset1:33
    v_mfma_f32_16x16x32_bf16 v[144:147], v[68:71], v[128:131], v[144:147]
    ds_read2_b32 v[90:91], v57 offset0:34 offset1:35
    v_mfma_f32_16x16x32_bf16 v[152:155], v[72:75], v[128:131], v[152:155]
    ds_read2_b32 v[92:93], v57 offset0:40 offset1:41
    v_mfma_f32_16x16x32_bf16 v[160:163], v[76:79], v[128:131], v[160:163]
    ds_read2_b32 v[94:95], v57 offset0:42 offset1:43
    v_mfma_f32_16x16x32_bf16 v[140:143], v[64:67], v[132:135], v[140:143]
    v_mfma_f32_16x16x32_bf16 v[148:151], v[68:71], v[132:135], v[148:151]
    v_mfma_f32_16x16x32_bf16 v[156:159], v[72:75], v[132:135], v[156:159]
    v_mfma_f32_16x16x32_bf16 v[164:167], v[76:79], v[132:135], v[164:167]
    s_waitcnt lgkmcnt(0)
    v_mfma_f32_16x16x32_bf16 v[136:139], v[72:75], v[104:107], v[136:139]
    ds_read_b128 v[120:123], v61 offset:960
    v_mfma_f32_16x16x32_bf16 v[144:147], v[76:79], v[104:107], v[144:147]
    ds_read_b128 v[124:127], v61 offset:3520
    v_mfma_f32_16x16x32_bf16 v[152:155], v[80:83], v[104:107], v[152:155]
    ds_read_b128 v[128:131], v61 offset:1024
    v_mfma_f32_16x16x32_bf16 v[160:163], v[84:87], v[104:107], v[160:163]
    ds_read_b128 v[132:135], v61 offset:3584
    v_mfma_f32_16x16x32_bf16 v[140:143], v[72:75], v[108:111], v[140:143]
    ds_read2_b32 v[96:97], v57 offset0:48 offset1:49
    v_mfma_f32_16x16x32_bf16 v[148:151], v[76:79], v[108:111], v[148:151]
    ds_read2_b32 v[98:99], v57 offset0:50 offset1:51
    v_mfma_f32_16x16x32_bf16 v[156:159], v[80:83], v[108:111], v[156:159]
    ds_read2_b32 v[100:101], v57 offset0:56 offset1:57
    v_mfma_f32_16x16x32_bf16 v[164:167], v[84:87], v[108:111], v[164:167]
    ds_read2_b32 v[102:103], v57 offset0:58 offset1:59
    v_mfma_f32_16x16x32_bf16 v[136:139], v[80:83], v[112:115], v[136:139]
    ds_read2_b32 v[64:65], v57 offset0:64 offset1:65
    v_mfma_f32_16x16x32_bf16 v[144:147], v[84:87], v[112:115], v[144:147]
    ds_read2_b32 v[66:67], v57 offset0:66 offset1:67
    v_mfma_f32_16x16x32_bf16 v[152:155], v[88:91], v[112:115], v[152:155]
    ds_read2_b32 v[68:69], v57 offset0:72 offset1:73
    v_mfma_f32_16x16x32_bf16 v[160:163], v[92:95], v[112:115], v[160:163]
    ds_read2_b32 v[70:71], v57 offset0:74 offset1:75
    v_mfma_f32_16x16x32_bf16 v[140:143], v[80:83], v[116:119], v[140:143]
    v_mfma_f32_16x16x32_bf16 v[148:151], v[84:87], v[116:119], v[148:151]
    v_mfma_f32_16x16x32_bf16 v[156:159], v[88:91], v[116:119], v[156:159]
    v_mfma_f32_16x16x32_bf16 v[164:167], v[92:95], v[116:119], v[164:167]
    s_waitcnt lgkmcnt(0)
    v_mfma_f32_16x16x32_bf16 v[136:139], v[88:91], v[120:123], v[136:139]
    ds_read_b128 v[104:107], v61 offset:800
    v_mfma_f32_16x16x32_bf16 v[144:147], v[92:95], v[120:123], v[144:147]
    ds_read_b128 v[108:111], v61 offset:3360
    v_mfma_f32_16x16x32_bf16 v[152:155], v[96:99], v[120:123], v[152:155]
    ds_read_b128 v[112:115], v61 offset:864
    v_mfma_f32_16x16x32_bf16 v[160:163], v[100:103], v[120:123], v[160:163]
    ds_read_b128 v[116:119], v61 offset:3424
    v_mfma_f32_16x16x32_bf16 v[140:143], v[88:91], v[124:127], v[140:143]
    ds_read2_b32 v[72:73], v57 offset0:80 offset1:81
    v_mfma_f32_16x16x32_bf16 v[148:151], v[92:95], v[124:127], v[148:151]
    ds_read2_b32 v[74:75], v57 offset0:82 offset1:83
    v_mfma_f32_16x16x32_bf16 v[156:159], v[96:99], v[124:127], v[156:159]
    ds_read2_b32 v[76:77], v57 offset0:88 offset1:89
    v_mfma_f32_16x16x32_bf16 v[164:167], v[100:103], v[124:127], v[164:167]
    ds_read2_b32 v[78:79], v57 offset0:90 offset1:91
    v_mfma_f32_16x16x32_bf16 v[136:139], v[96:99], v[128:131], v[136:139]
    ds_read2_b32 v[80:81], v57 offset0:96 offset1:97
    v_mfma_f32_16x16x32_bf16 v[144:147], v[100:103], v[128:131], v[144:147]
    ds_read2_b32 v[82:83], v57 offset0:98 offset1:99
    v_mfma_f32_16x16x32_bf16 v[152:155], v[64:67], v[128:131], v[152:155]
    ds_read2_b32 v[84:85], v57 offset0:104 offset1:105
    v_mfma_f32_16x16x32_bf16 v[160:163], v[68:71], v[128:131], v[160:163]
    ds_read2_b32 v[86:87], v57 offset0:106 offset1:107
    v_mfma_f32_16x16x32_bf16 v[140:143], v[96:99], v[132:135], v[140:143]
    v_mfma_f32_16x16x32_bf16 v[148:151], v[100:103], v[132:135], v[148:151]
    v_mfma_f32_16x16x32_bf16 v[156:159], v[64:67], v[132:135], v[156:159]
    v_mfma_f32_16x16x32_bf16 v[164:167], v[68:71], v[132:135], v[164:167]
    s_waitcnt lgkmcnt(0)
    v_mfma_f32_16x16x32_bf16 v[136:139], v[64:67], v[104:107], v[136:139]
    ds_read_b128 v[120:123], v61 offset:640
    v_mfma_f32_16x16x32_bf16 v[144:147], v[68:71], v[104:107], v[144:147]
    ds_read_b128 v[124:127], v61 offset:3200
    v_mfma_f32_16x16x32_bf16 v[152:155], v[72:75], v[104:107], v[152:155]
    ds_read_b128 v[128:131], v61 offset:704
    v_mfma_f32_16x16x32_bf16 v[160:163], v[76:79], v[104:107], v[160:163]
    ds_read_b128 v[132:135], v61 offset:3264
    v_mfma_f32_16x16x32_bf16 v[140:143], v[64:67], v[108:111], v[140:143]
    ds_read2_b32 v[88:89], v57 offset0:112 offset1:113
    v_mfma_f32_16x16x32_bf16 v[148:151], v[68:71], v[108:111], v[148:151]
    ds_read2_b32 v[90:91], v57 offset0:114 offset1:115
    v_mfma_f32_16x16x32_bf16 v[156:159], v[72:75], v[108:111], v[156:159]
    ds_read2_b32 v[92:93], v57 offset0:120 offset1:121
    v_mfma_f32_16x16x32_bf16 v[164:167], v[76:79], v[108:111], v[164:167]
    ds_read2_b32 v[94:95], v57 offset0:122 offset1:123
    v_mfma_f32_16x16x32_bf16 v[136:139], v[72:75], v[112:115], v[136:139]
    ds_read2_b32 v[96:97], v57 offset0:128 offset1:129
    v_mfma_f32_16x16x32_bf16 v[144:147], v[76:79], v[112:115], v[144:147]
    ds_read2_b32 v[98:99], v57 offset0:130 offset1:131
    v_mfma_f32_16x16x32_bf16 v[152:155], v[80:83], v[112:115], v[152:155]
    ds_read2_b32 v[100:101], v57 offset0:136 offset1:137
    v_mfma_f32_16x16x32_bf16 v[160:163], v[84:87], v[112:115], v[160:163]
    ds_read2_b32 v[102:103], v57 offset0:138 offset1:139
    v_mfma_f32_16x16x32_bf16 v[140:143], v[72:75], v[116:119], v[140:143]
    v_mfma_f32_16x16x32_bf16 v[148:151], v[76:79], v[116:119], v[148:151]
    v_mfma_f32_16x16x32_bf16 v[156:159], v[80:83], v[116:119], v[156:159]
    v_mfma_f32_16x16x32_bf16 v[164:167], v[84:87], v[116:119], v[164:167]
    s_waitcnt lgkmcnt(0)
    v_mfma_f32_16x16x32_bf16 v[136:139], v[80:83], v[120:123], v[136:139]
    v_mfma_f32_16x16x32_bf16 v[144:147], v[84:87], v[120:123], v[144:147]
    v_mfma_f32_16x16x32_bf16 v[152:155], v[88:91], v[120:123], v[152:155]
    v_mfma_f32_16x16x32_bf16 v[160:163], v[92:95], v[120:123], v[160:163]
    v_mfma_f32_16x16x32_bf16 v[140:143], v[80:83], v[124:127], v[140:143]
    v_mfma_f32_16x16x32_bf16 v[148:151], v[84:87], v[124:127], v[148:151]
    v_mfma_f32_16x16x32_bf16 v[156:159], v[88:91], v[124:127], v[156:159]
    v_mfma_f32_16x16x32_bf16 v[164:167], v[92:95], v[124:127], v[164:167]
    v_mfma_f32_16x16x32_bf16 v[136:139], v[88:91], v[128:131], v[136:139]
    v_mfma_f32_16x16x32_bf16 v[144:147], v[92:95], v[128:131], v[144:147]
    v_mfma_f32_16x16x32_bf16 v[152:155], v[96:99], v[128:131], v[152:155]
    v_mfma_f32_16x16x32_bf16 v[160:163], v[100:103], v[128:131], v[160:163]
    v_mfma_f32_16x16x32_bf16 v[140:143], v[88:91], v[132:135], v[140:143]
    v_mfma_f32_16x16x32_bf16 v[148:151], v[92:95], v[132:135], v[148:151]
    v_mfma_f32_16x16x32_bf16 v[156:159], v[96:99], v[132:135], v[156:159]
    v_mfma_f32_16x16x32_bf16 v[164:167], v[100:103], v[132:135], v[164:167]
    s_branch K2_EPI
K2_Q2:
    ds_read2_b32 v[96:97], v57 offset0:128 offset1:129
    ds_read2_b32 v[98:99], v57 offset0:130 offset1:131
    ds_read2_b32 v[100:101], v57 offset0:136 offset1:137
    ds_read2_b32 v[102:103], v57 offset0:138 offset1:139
    ds_read2_b32 v[64:65], v57 offset0:144 offset1:145
    ds_read2_b32 v[66:67], v57 offset0:146 offset1:147
    ds_read2_b32 v[68:69], v57 offset0:152 offset1:153
    ds_read2_b32 v[70:71], v57 offset0:154 offset1:155
    ds_read2_b32 v[72:73], v57 offset0:160 offset1:161
    ds_read2_b32 v[74:75], v57 offset0:162 offset1:163
    ds_read2_b32 v[76:77], v57 offset0:168 offset1:169
    ds_read2_b32 v[78:79], v57 offset0:170 offset1:171
    ds_read_b128 v[104:107], v61 offset:480
    ds_read_b128 v[108:111], v61 offset:3040
    ds_read_b128 v[112:115], v61 offset:544
    ds_read_b128 v[116:119], v61 offset:3104
    s_waitcnt lgkmcnt(0)
    v_mfma_f32_16x16x32_bf16 v[136:139], v[96:99], v[104:107], 0
    ds_read_b128 v[120:123], v61 offset:320
    v_mfma_f32_16x16x32_bf16 v[144:147], v[100:103], v[104:107], 0
    ds_read_b128 v[124:127], v61 offset:2880
    v_mfma_f32_16x16x32_bf16 v[152:155], v[64:67], v[104:107], 0
    ds_read_b128 v[128:131], v61 offset:384
    v_mfma_f32_16x16x32_bf16 v[160:163], v[68:71], v[104:107], 0
    ds_read_b128 v[132:135], v61 offset:2944
    v_mfma_f32_16x16x32_bf16 v[140:143], v[96:99], v[108:111], 0
    ds_read2_b32 v[80:81], v57 offset0:176 offset1:177
    v_mfma_f32_16x16x32_bf16 v[148:151], v[100:103], v[108:111], 0
    ds_read2_b32 v[82:83], v57 offset0:178 offset1:179
    v_mfma_f32_16x16x32_bf16 v[156:159], v[64:67], v[108:111], 0
    ds_read2_b32 v[84:85], v57 offset0:184 offset1:185
    v_mfma_f32_16x16x32_bf16 v[164:167], v[68:71], v[108:111], 0
    ds_read2_b32 v[86:87], v57 offset0:186 offset1:187
    v_mfma_f32_16x16x32_bf16 v[136:139], v[64:67], v[112:115], v[136:139]
    ds_read2_b32 v[88:89], v57 offset0:192 offset1:193
    v_mfma_f32_16x16x32_bf16 v[144:147], v[68:71], v[112:115], v[144:147]
    ds_read2_b32 v[90:91], v57 offset0:194 offset1:195
    v_mfma_f32_16x16x32_bf16 v[152:155], v[72:75], v[112:115], v[152:155]
    ds_read2_b32 v[92:93], v57 offset0:200 offset1:201
    v_mfma_f32_16x16x32_bf16 v[160:163], v[76:79], v[112:115], v[160:163]
    ds_read2_b32 v[94:95], v57 offset0:202 offset1:203
    v_mfma_f32_16x16x32_bf16 v[140:143], v[64:67], v[116:119], v[140:143]
    v_mfma_f32_16x16x32_bf16 v[148:151], v[68:71], v[116:119], v[148:151]
    v_mfma_f32_16x16x32_bf16 v[156:159], v[72:75], v[116:119], v[156:159]
    v_mfma_f32_16x16x32_bf16 v[164:167], v[76:79], v[116:119], v[164:167]
    s_waitcnt lgkmcnt(0)
    v_mfma_f32_16x16x32_bf16 v[136:139], v[72:75], v[120:123], v[136:139]
    ds_read_b128 v[104:107], v61 offset:160
    v_mfma_f32_16x16x32_bf16 v[144:147], v[76:79], v[120:123], v[144:147]
    ds_read_b128 v[108:111], v61 offset:2720
    v_mfma_f32_16x16x32_bf16 v[152:155], v[80:83], v[120:123], v[152:155]
    ds_read_b128 v[112:115], v61 offset:224
    v_mfma_f32_16x16x32_bf16 v[160:163], v[84:87], v[120:123], v[160:163]
    ds_read_b128 v[116:119], v61 offset:2784
    v_mfma_f32_16x16x32_bf16 v[140:143], v[72:75], v[124:127], v[140:143]
    ds_read2_b32 v[96:97], v57 offset0:208 offset1:209
    v_mfma_f32_16x16x32_bf16 v[148:151], v[76:79], v[124:127], v[148:151]
    ds_read2_b32 v[98:99], v57 offset0:210 offset1:211
    v_mfma_f32_16x16x32_bf16 v[156:159], v[80:83], v[124:127], v[156:159]
    ds_read2_b32 v[100:101], v57 offset0:216 offset1:217
    v_mfma_f32_16x16x32_bf16 v[164:167], v[84:87], v[124:127], v[164:167]
    ds_read2_b32 v[102:103], v57 offset0:218 offset1:219
    v_mfma_f32_16x16x32_bf16 v[136:139], v[80:83], v[128:131], v[136:139]
    ds_read2_b32 v[64:65], v57 offset0:224 offset1:225
    v_mfma_f32_16x16x32_bf16 v[144:147], v[84:87], v[128:131], v[144:147]
    ds_read2_b32 v[66:67], v57 offset0:226 offset1:227
    v_mfma_f32_16x16x32_bf16 v[152:155], v[88:91], v[128:131], v[152:155]
    ds_read2_b32 v[68:69], v57 offset0:232 offset1:233
    v_mfma_f32_16x16x32_bf16 v[160:163], v[92:95], v[128:131], v[160:163]
    ds_read2_b32 v[70:71], v57 offset0:234 offset1:235
    v_mfma_f32_16x16x32_bf16 v[140:143], v[80:83], v[132:135], v[140:143]
    v_mfma_f32_16x16x32_bf16 v[148:151], v[84:87], v[132:135], v[148:151]
    v_mfma_f32_16x16x32_bf16 v[156:159], v[88:91], v[132:135], v[156:159]
    v_mfma_f32_16x16x32_bf16 v[164:167], v[92:95], v[132:135], v[164:167]
    s_waitcnt lgkmcnt(0)
    v_mfma_f32_16x16x32_bf16 v[136:139], v[88:91], v[104:107], v[136:139]
    ds_read_b128 v[120:123], v61 offset:0
    v_mfma_f32_16x16x32_bf16 v[144:147], v[92:95], v[104:107], v[144:147]
    ds_read_b128 v[124:127], v61 offset:2560
    v_mfma_f32_16x16x32_bf16 v[152:155], v[96:99], v[104:107], v[152:155]
    ds_read_b128 v[128:131], v61 offset:64
    v_mfma_f32_16x16x32_bf16 v[160:163], v[100:103], v[104:107], v[160:163]
    ds_read_b128 v[132:135], v61 offset:2624
    v_mfma_f32_16x16x32_bf16 v[140:143], v[88:91], v[108:111], v[140:143]
    ds_read2_b32 v[72:73], v57 offset0:240 offset1:241
    v_mfma_f32_16x16x32_bf16 v[148:151], v[92:95], v[108:111], v[148:151]
    ds_read2_b32 v[74:75], v57 offset0:242 offset1:243
    v_mfma_f32_16x16x32_bf16 v[156:159], v[96:99], v[108:111], v[156:159]
    ds_read2_b32 v[76:77], v57 offset0:248 offset1:249
    v_mfma_f32_16x16x32_bf16 v[164:167], v[100:103], v[108:111], v[164:167]
    ds_read2_b32 v[78:79], v57 offset0:250 offset1:251
    v_mfma_f32_16x16x32_bf16 v[136:139], v[96:99], v[112:115], v[136:139]
    ds_read2_b32 v[80:81], v58 offset0:0 offset1:1
    v_mfma_f32_16x16x32_bf16 v[144:147], v[100:103], v[112:115], v[144:147]
    ds_read2_b32 v[82:83], v58 offset0:2 offset1:3
    v_mfma_f32_16x16x32_bf16 v[152:155], v[64:67], v[112:115], v[152:155]
    ds_read2_b32 v[84:85], v58 offset0:8 offset1:9
    v_mfma_f32_16x16x32_bf16 v[160:163], v[68:71], v[112:115], v[160:163]
    ds_read2_b32 v[86:87], v58 offset0:10 offset1:11
    v_mfma_f32_16x16x32_bf16 v[140:143], v[96:99], v[116:119], v[140:143]
    v_mfma_f32_16x16x32_bf16 v[148:151], v[100:103], v[116:119], v[148:151]
    v_mfma_f32_16x16x32_bf16 v[156:159], v[64:67], v[116:119], v[156:159]
    v_mfma_f32_16x16x32_bf16 v[164:167], v[68:71], v[116:119], v[164:167]
    s_waitcnt lgkmcnt(0)
    v_mfma_f32_16x16x32_bf16 v[136:139], v[64:67], v[120:123], v[136:139]
    ds_read_b128 v[108:111], v61 offset:2400
    v_mfma_f32_16x16x32_bf16 v[144:147], v[68:71], v[120:123], v[144:147]
    ds_read_b128 v[116:119], v61 offset:2464
    v_mfma_f32_16x16x32_bf16 v[152:155], v[72:75], v[120:123], v[152:155]
    ds_read2_b32 v[88:89], v58 offset0:16 offset1:17
    v_mfma_f32_16x16x32_bf16 v[160:163], v[76:79], v[120:123], v[160:163]
    ds_read2_b32 v[90:91], v58 offset0:18 offset1:19
    v_mfma_f32_16x16x32_bf16 v[140:143], v[64:67], v[124:127], v[140:143]
    ds_read2_b32 v[92:93], v58 offset0:24 offset1:25
    v_mfma_f32_16x16x32_bf16 v[148:151], v[68:71], v[124:127], v[148:151]
    ds_read2_b32 v[94:95], v58 offset0:26 offset1:27
    v_mfma_f32_16x16x32_bf16 v[156:159], v[72:75], v[124:127], v[156:159]
    ds_read2_b32 v[96:97], v58 offset0:32 offset1:33
    v_mfma_f32_16x16x32_bf16 v[164:167], v[76:79], v[124:127], v[164:167]
    ds_read2_b32 v[98:99], v58 offset0:34 offset1:35
    v_mfma_f32_16x16x32_bf16 v[136:139], v[72:75], v[128:131], v[136:139]
    ds_read2_b32 v[100:101], v58 offset0:40 offset1:41
    v_mfma_f32_16x16x32_bf16 v[144:147], v[76:79], v[128:131], v[144:147]
    ds_read2_b32 v[102:103], v58 offset0:42 offset1:43
    v_mfma_f32_16x16x32_bf16 v[152:155], v[80:83], v[128:131], v[152:155]
    v_mfma_f32_16x16x32_bf16 v[160:163], v[84:87], v[128:131], v[160:163]
    v_mfma_f32_16x16x32_bf16 v[140:143], v[72:75], v[132:135], v[140:143]
    v_mfma_f32_16x16x32_bf16 v[148:151], v[76:79], v[132:135], v[148:151]
    v_mfma_f32_16x16x32_bf16 v[156:159], v[80:83], v[132:135], v[156:159]
    v_mfma_f32_16x16x32_bf16 v[164:167], v[84:87], v[132:135], v[164:167]
    s_waitcnt lgkmcnt(0)
    v_mfma_f32_16x16x32_bf16 v[140:143], v[80:83], v[108:111], v[140:143]
    ds_read_b128 v[124:127], v61 offset:2240
    ds_read_b128 v[132:135], v61 offset:2304
    v_mfma_f32_16x16x32_bf16 v[148:151], v[84:87], v[108:111], v[148:151]
    ds_read2_b32 v[64:65], v58 offset0:48 offset1:49
    ds_read2_b32 v[66:67], v58 offset0:50 offset1:51
    v_mfma_f32_16x16x32_bf16 v[156:159], v[88:91], v[108:111], v[156:159]
    ds_read2_b32 v[68:69], v58 offset0:56 offset1:57
    ds_read2_b32 v[70:71], v58 offset0:58 offset1:59
    v_mfma_f32_16x16x32_bf16 v[164:167], v[92:95], v[108:111], v[164:167]
    ds_read2_b32 v[72:73], v58 offset0:64 offset1:65
    ds_read2_b32 v[74:75], v58 offset0:66 offset1:67
    v_mfma_f32_16x16x32_bf16 v[140:143], v[88:91], v[116:119], v[140:143]
    ds_read2_b32 v[76:77], v58 offset0:72 offset1:73
    ds_read2_b32 v[78:79], v58 offset0:74 offset1:75
    v_mfma_f32_16x16x32_bf16 v[148:151], v[92:95], v[116:119], v[148:151]
    v_mfma_f32_16x16x32_bf16 v[156:159], v[96:99], v[116:119], v[156:159]
    v_mfma_f32_16x16x32_bf16 v[164:167], v[100:103], v[116:119], v[164:167]
    s_waitcnt lgkmcnt(0)
    v_mfma_f32_16x16x32_bf16 v[140:143], v[96:99], v[124:127], v[140:143]
    ds_read_b128 v[108:111], v61 offset:2080
    ds_read_b128 v[116:119], v61 offset:2144
    v_mfma_f32_16x16x32_bf16 v[148:151], v[100:103], v[124:127], v[148:151]
    ds_read2_b32 v[80:81], v58 offset0:80 offset1:81
    ds_read2_b32 v[82:83], v58 offset0:82 offset1:83
    v_mfma_f32_16x16x32_bf16 v[156:159], v[64:67], v[124:127], v[156:159]
    ds_read2_b32 v[84:85], v58 offset0:88 offset1:89
    ds_read2_b32 v[86:87], v58 offset0:90 offset1:91
    v_mfma_f32_16x16x32_bf16 v[164:167], v[68:71], v[124:127], v[164:167]
    ds_read2_b32 v[88:89], v58 offset0:96 offset1:97
    ds_read2_b32 v[90:91], v58 offset0:98 offset1:99
    v_mfma_f32_16x16x32_bf16 v[140:143], v[64:67], v[132:135], v[140:143]
    ds_read2_b32 v[92:93], v58 offset0:104 offset1:105
    ds_read2_b32 v[94:95], v58 offset0:106 offset1:107
    v_mfma_f32_16x16x32_bf16 v[148:151], v[68:71], v[132:135], v[148:151]
    v_mfma_f32_16x16x32_bf16 v[156:159], v[72:75], v[132:135], v[156:159]
    v_mfma_f32_16x16x32_bf16 v[164:167], v[76:79], v[132:135], v[164:167]
    s_waitcnt lgkmcnt(0)
    v_mfma_f32_16x16x32_bf16 v[140:143], v[72:75], v[108:111], v[140:143]
    ds_read_b128 v[124:127], v61 offset:1920
    ds_read_b128 v[132:135], v61 offset:1984
    v_mfma_f32_16x16x32_bf16 v[148:151], v[76:79], v[108:111], v[148:151]
    ds_read2_b32 v[96:97], v58 offset0:112 offset1:113
    ds_read2_b32 v[98:99], v58 offset0:114 offset1:115
    v_mfma_f32_16x16x32_bf16 v[156:159], v[80:83], v[108:111], v[156:159]
    ds_read2_b32 v[100:101], v58 offset0:120 offset1:121
    ds_read2_b32 v[102:103], v58 offset0:122 offset1:123
    v_mfma_f32_16x16x32_bf16 v[164:167], v[84:87], v[108:111], v[164:167]
    ds_read2_b32 v[64:65], v58 offset0:128 offset1:129
    ds_read2_b32 v[66:67], v58 offset0:130 offset1:131
    v_mfma_f32_16x16x32_bf16 v[140:143], v[80:83], v[116:119], v[140:143]
    ds_read2_b32 v[68:69], v58 offset0:136 offset1:137
    ds_read2_b32 v[70:71], v58 offset0:138 offset1:139
    v_mfma_f32_16x16x32_bf16 v[148:151], v[84:87], v[116:119], v[148:151]
    v_mfma_f32_16x16x32_bf16 v[156:159], v[88:91], v[116:119], v[156:159]
    v_mfma_f32_16x16x32_bf16 v[164:167], v[92:95], v[116:119], v[164:167]
    s_waitcnt lgkmcnt(0)
    v_mfma_f32_16x16x32_bf16 v[140:143], v[88:91], v[124:127], v[140:143]
    v_mfma_f32_16x16x32_bf16 v[148:151], v[92:95], v[124:127], v[148:151]
    v_mfma_f32_16x16x32_bf16 v[156:159], v[96:99], v[124:127], v[156:159]
    v_mfma_f32_16x16x32_bf16 v[164:167], v[100:103], v[124:127], v[164:167]
    v_mfma_f32_16x16x32_bf16 v[140:143], v[96:99], v[132:135], v[140:143]
    v_mfma_f32_16x16x32_bf16 v[148:151], v[100:103], v[132:135], v[148:151]
    v_mfma_f32_16x16x32_bf16 v[156:159], v[64:67], v[132:135], v[156:159]
    v_mfma_f32_16x16x32_bf16 v[164:167], v[68:71], v[132:135], v[164:167]
    s_branch K2_EPI
K2_Q3:
    ds_read2_b32 v[64:65], v58 offset0:128 offset1:129
    ds_read2_b32 v[66:67], v58 offset0:130 offset1:131
    ds_read2_b32 v[68:69], v58 offset0:136 offset1:137
    ds_read2_b32 v[70:71], v58 offset0:138 offset1:139
    ds_read2_b32 v[72:73], v58 offset0:144 offset1:145
    ds_read2_b32 v[74:75], v58 offset0:146 offset1:147
    ds_read2_b32 v[76:77], v58 offset0:152 offset1:153
    ds_read2_b32 v[78:79], v58 offset0:154 offset1:155
    ds_read2_b32 v[80:81], v58 offset0:160 offset1:161
    ds_read2_b32 v[82:83], v58 offset0:162 offset1:163
    ds_read2_b32 v[84:85], v58 offset0:168 offset1:169
    ds_read2_b32 v[86:87], v58 offset0:170 offset1:171
    ds_read_b128 v[108:111], v61 offset:1760
    ds_read_b128 v[116:119], v61 offset:1824
    v_mov_b32 v136, 0
    v_mov_b32 v137, 0
    v_mov_b32 v138, 0
    v_mov_b32 v139, 0
    v_mov_b32 v144, 0
    v_mov_b32 v145, 0
    v_mov_b32 v146, 0
    v_mov_b32 v147, 0
    v_mov_b32 v152, 0
    v_mov_b32 v153, 0
    v_mov_b32 v154, 0
    v_mov_b32 v155, 0
    v_mov_b32 v160, 0
    v_mov_b32 v161, 0
    v_mov_b32 v162, 0
    v_mov_b32 v163, 0
    s_waitcnt lgkmcnt(0)
    v_mfma_f32_16x16x32_bf16 v[140:143], v[64:67], v[108:111], 0
    ds_read_b128 v[124:127], v61 offset:1600
    ds_read_b128 v[132:135], v61 offset:1664
    v_mfma_f32_16x16x32_bf16 v[148:151], v[68:71], v[108:111], 0
    ds_read2_b32 v[88:89], v58 offset0:176 offset1:177
    ds_read2_b32 v[90:91], v58 offset0:178 offset1:179
    v_mfma_f32_16x16x32_bf16 v[156:159], v[72:75], v[108:111], 0
    ds_read2_b32 v[92:93], v58 offset0:184 offset1:185
    ds_read2_b32 v[94:95], v58 offset0:186 offset1:187
    v_mfma_f32_16x16x32_bf16 v[164:167], v[76:79], v[108:111], 0
    ds_read2_b32 v[96:97], v58 offset0:192 offset1:193
    ds_read2_b32 v[98:99], v58 offset0:194 offset1:195
    v_mfma_f32_16x16x32_bf16 v[140:143], v[72:75], v[116:119], v[140:143]
    ds_read2_b32 v[100:101], v58 offset0:200 offset1:201
    ds_read2_b32 v[102:103], v58 offset0:202 offset1:203
    v_mfma_f32_16x16x32_bf16 v[148:151], v[76:79], v[116:119], v[148:151]
    v_mfma_f32_16x16x32_bf16 v[156:159], v[80:83], v[116:119], v[156:159]
    v_mfma_f32_16x16x32_bf16 v[164:167], v[84:87], v[116:119], v[164:167]
    s_waitcnt lgkmcnt(0)
    v_mfma_f32_16x16x32_bf16 v[140:143], v[80:83], v[124:127], v[140:143]
    ds_read_b128 v[108:111], v61 offset:1440
    ds_read_b128 v[116:119], v61 offset:1504
    v_mfma_f32_16x16x32_bf16 v[148:151], v[84:87], v[124:127], v[148:151]
    ds_read2_b32 v[64:65], v58 offset0:208 offset1:209
    ds_read2_b32 v[66:67], v58 offset0:210 offset1:211
    v_mfma_f32_16x16x32_bf16 v[156:159], v[88:91], v[124:127], v[156:159]
    ds_read2_b32 v[68:69], v58 offset0:216 offset1:217
    ds_read2_b32 v[70:71], v58 offset0:218 offset1:219
    v_mfma_f32_16x16x32_bf16 v[164:167], v[92:95], v[124:127], v[164:167]
    ds_read2_b32 v[72:73], v58 offset0:224 offset1:225
    ds_read2_b32 v[74:75], v58 offset0:226 offset1:227
    v_mfma_f32_16x16x32_bf16 v[140:143], v[88:91], v[132:135], v[140:143]
    ds_read2_b32 v[76:77], v58 offset0:232 offset1:233
    ds_read2_b32 v[78:79], v58 offset0:234 offset1:235
    v_mfma_f32_16x16x32_bf16 v[148:151], v[92:95], v[132:135], v[148:151]
    v_mfma_f32_16x16x32_bf16 v[156:159], v[96:99], v[132:135], v[156:159]
    v_mfma_f32_16x16x32_bf16 v[164:167], v[100:103], v[132:135], v[164:167]
    s_waitcnt lgkmcnt(0)
    v_mfma_f32_16x16x32_bf16 v[140:143], v[96:99], v[108:111], v[140:143]
    ds_read_b128 v[124:127], v61 offset:1280
    ds_read_b128 v[132:135], v61 offset:1344
    v_mfma_f32_16x16x32_bf16 v[148:151], v[100:103], v[108:111], v[148:151]
    ds_read2_b32 v[80:81], v58 offset0:240 offset1:241
    ds_read2_b32 v[82:83], v58 offset0:242 offset1:243
    v_mfma_f32_16x16x32_bf16 v[156:159], v[64:67], v[108:111], v[156:159]
    ds_read2_b32 v[84:85], v58 offset0:248 offset1:249
    ds_read2_b32 v[86:87], v58 offset0:250 offset1:251
    v_mfma_f32_16x16x32_bf16 v[164:167], v[68:71], v[108:111], v[164:167]
    ds_read2_b32 v[88:89], v59 offset0:0 offset1:1
    ds_read2_b32 v[90:91], v59 offset0:2 offset1:3
    v_mfma_f32_16x16x32_bf16 v[140:143], v[64:67], v[116:119], v[140:143]
    ds_read2_b32 v[92:93], v59 offset0:8 offset1:9
    ds_read2_b32 v[94:95], v59 offset0:10 offset1:11
    v_mfma_f32_16x16x32_bf16 v[148:151], v[68:71], v[116:119], v[148:151]
    v_mfma_f32_16x16x32_bf16 v[156:159], v[72:75], v[116:119], v[156:159]
    v_mfma_f32_16x16x32_bf16 v[164:167], v[76:79], v[116:119], v[164:167]
    s_waitcnt lgkmcnt(0)
    v_mfma_f32_16x16x32_bf16 v[140:143], v[72:75], v[124:127], v[140:143]
    ds_read_b128 v[108:111], v61 offset:1120
    ds_read_b128 v[116:119], v61 offset:1184
    v_mfma_f32_16x16x32_bf16 v[148:151], v[76:79], v[124:127], v[148:151]
    ds_read2_b32 v[96:97], v59 offset0:16 offset1:17
    ds_read2_b32 v[98:99], v59 offset0:18 offset1:19
    v_mfma_f32_16x16x32_bf16 v[156:159], v[80:83], v[124:127], v[156:159]
    ds_read2_b32 v[100:101], v59 offset0:24 offset1:25
    ds_read2_b32 v[102:103], v59 offset0:26 offset1:27
    v_mfma_f32_16x16x32_bf16 v[164:167], v[84:87], v[124:127], v[164:167]
    ds_read2_b32 v[64:65], v59 offset0:32 offset1:33
    ds_read2_b32 v[66:67], v59 offset0:34 offset1:35
    v_mfma_f32_16x16x32_bf16 v[140:143], v[80:83], v[132:135], v[140:143]
    ds_read2_b32 v[68:69], v59 offset0:40 offset1:41
    ds_read2_b32 v[70:71], v59 offset0:42 offset1:43
    v_mfma_f32_16x16x32_bf16 v[148:151], v[84:87], v[132:135], v[148:151]
    v_mfma_f32_16x16x32_bf16 v[156:159], v[88:91], v[132:135], v[156:159]
    v_mfma_f32_16x16x32_bf16 v[164:167], v[92:95], v[132:135], v[164:167]
    s_waitcnt lgkmcnt(0)
    v_mfma_f32_16x16x32_bf16 v[140:143], v[88:91], v[108:111], v[140:143]
    ds_read_b128 v[124:127], v61 offset:960
    ds_read_b128 v[132:135], v61 offset:1024
    v_mfma_f32_16x16x32_bf16 v[148:151], v[92:95], v[108:111], v[148:151]
    ds_read2_b32 v[72:73], v59 offset0:48 offset1:49
    ds_read2_b32 v[74:75], v59 offset0:50 offset1:51
    v_mfma_f32_16x16x32_bf16 v[156:159], v[96:99], v[108:111], v[156:159]
    ds_read2_b32 v[76:77], v59 offset0:56 offset1:57
    ds_read2_b32 v[78:79], v59 offset0:58 offset1:59
    v_mfma_f32_16x16x32_bf16 v[164:167], v[100:103], v[108:111], v[164:167]
    ds_read2_b32 v[80:81], v59 offset0:64 offset1:65
    ds_read2_b32 v[82:83], v59 offset0:66 offset1:67
    v_mfma_f32_16x16x32_bf16 v[140:143], v[96:99], v[116:119], v[140:143]
    ds_read2_b32 v[84:85], v59 offset0:72 offset1:73
    ds_read2_b32 v[86:87], v59 offset0:74 offset1:75
    v_mfma_f32_16x16x32_bf16 v[148:151], v[100:103], v[116:119], v[148:151]
    v_mfma_f32_16x16x32_bf16 v[156:159], v[64:67], v[116:119], v[156:159]
    v_mfma_f32_16x16x32_bf16 v[164:167], v[68:71], v[116:119], v[164:167]
    s_waitcnt lgkmcnt(0)
    v_mfma_f32_16x16x32_bf16 v[140:143], v[64:67], v[124:127], v[140:143]
    ds_read_b128 v[108:111], v61 offset:800
    ds_read_b128 v[116:119], v61 offset:864
    v_mfma_f32_16x16x32_bf16 v[148:151], v[68:71], v[124:127], v[148:151]
    ds_read2_b32 v[88:89], v59 offset0:80 offset1:81
    ds_read2_b32 v[90:91], v59 offset0:82 offset1:83
    v_mfma_f32_16x16x32_bf16 v[156:159], v[72:75], v[124:127], v[156:159]
    ds_read2_b32 v[92:93], v59 offset0:88 offset1:89
    ds_read2_b32 v[94:95], v59 offset0:90 offset1:91
    v_mfma_f32_16x16x32_bf16 v[164:167], v[76:79], v[124:127], v[164:167]
    ds_read2_b32 v[96:97], v59 offset0:96 offset1:97
    ds_read2_b32 v[98:99], v59 offset0:98 offset1:99
    v_mfma_f32_16x16x32_bf16 v[140:143], v[72:75], v[132:135], v[140:143]
    ds_read2_b32 v[100:101], v59 offset0:104 offset1:105
    ds_read2_b32 v[102:103], v59 offset0:106 offset1:107
    v_mfma_f32_16x16x32_bf16 v[148:151], v[76:79], v[132:135], v[148:151]
    v_mfma_f32_16x16x32_bf16 v[156:159], v[80:83], v[132:135], v[156:159]
    v_mfma_f32_16x16x32_bf16 v[164:167], v[84:87], v[132:135], v[164:167]
    s_waitcnt lgkmcnt(0)
    v_mfma_f32_16x16x32_bf16 v[140:143], v[80:83], v[108:111], v[140:143]
    ds_read_b128 v[124:127], v61 offset:640
    ds_read_b128 v[132:135], v61 offset:704
    v_mfma_f32_16x16x32_bf16 v[148:151], v[84:87], v[108:111], v[148:151]
    ds_read2_b32 v[64:65], v59 offset0:112 offset1:113
    ds_read2_b32 v[66:67], v59 offset0:114 offset1:115
    v_mfma_f32_16x16x32_bf16 v[156:159], v[88:91], v[108:111], v[156:159]
    ds_read2_b32 v[68:69], v59 offset0:120 offset1:121
    ds_read2_b32 v[70:71], v59 offset0:122 offset1:123
    v_mfma_f32_16x16x32_bf16 v[164:167], v[92:95], v[108:111], v[164:167]
    ds_read2_b32 v[72:73], v59 offset0:128 offset1:129
    ds_read2_b32 v[74:75], v59 offset0:130 offset1:131
    v_mfma_f32_16x16x32_bf16 v[140:143], v[88:91], v[116:119], v[140:143]
    ds_read2_b32 v[76:77], v59 offset0:136 offset1:137
    ds_read2_b32 v[78:79], v59 offset0:138 offset1:139
    v_mfma_f32_16x16x32_bf16 v[148:151], v[92:95], v[116:119], v[148:151]
    v_mfma_f32_16x16x32_bf16 v[156:159], v[96:99], v[116:119], v[156:159]
    v_mfma_f32_16x16x32_bf16 v[164:167], v[100:103], v[116:119], v[164:167]
    s_waitcnt lgkmcnt(0)
    v_mfma_f32_16x16x32_bf16 v[140:143], v[96:99], v[124:127], v[140:143]
    ds_read_b128 v[108:111], v61 offset:480
    ds_read_b128 v[116:119], v61 offset:544
    v_mfma_f32_16x16x32_bf16 v[148:151], v[100:103], v[124:127], v[148:151]
    ds_read2_b32 v[80:81], v59 offset0:144 offset1:145
    ds_read2_b32 v[82:83], v59 offset0:146 offset1:147
    v_mfma_f32_16x16x32_bf16 v[156:159], v[64:67], v[124:127], v[156:159]
    ds_read2_b32 v[84:85], v59 offset0:152 offset1:153
    ds_read2_b32 v[86:87], v59 offset0:154 offset1:155
    v_mfma_f32_16x16x32_bf16 v[164:167], v[68:71], v[124:127], v[164:167]
    ds_read2_b32 v[88:89], v59 offset0:160 offset1:161
    ds_read2_b32 v[90:91], v59 offset0:162 offset1:163
    v_mfma_f32_16x16x32_bf16 v[140:143], v[64:67], v[132:135], v[140:143]
    ds_read2_b32 v[92:93], v59 offset0:168 offset1:169
    ds_read2_b32 v[94:95], v59 offset0:170 offset1:171
    v_mfma_f32_16x16x32_bf16 v[148:151], v[68:71], v[132:135], v[148:151]
    v_mfma_f32_16x16x32_bf16 v[156:159], v[72:75], v[132:135], v[156:159]
    v_mfma_f32_16x16x32_bf16 v[164:167], v[76:79], v[132:135], v[164:167]
    s_waitcnt lgkmcnt(0)
    v_mfma_f32_16x16x32_bf16 v[140:143], v[72:75], v[108:111], v[140:143]
    ds_read_b128 v[124:127], v61 offset:320
    ds_read_b128 v[132:135], v61 offset:384
    v_mfma_f32_16x16x32_bf16 v[148:151], v[76:79], v[108:111], v[148:151]
    ds_read2_b32 v[96:97], v59 offset0:176 offset1:177
    ds_read2_b32 v[98:99], v59 offset0:178 offset1:179
    v_mfma_f32_16x16x32_bf16 v[156:159], v[80:83], v[108:111], v[156:159]
    ds_read2_b32 v[100:101], v59 offset0:184 offset1:185
    ds_read2_b32 v[102:103], v59 offset0:186 offset1:187
    v_mfma_f32_16x16x32_bf16 v[164:167], v[84:87], v[108:111], v[164:167]
    ds_read2_b32 v[64:65], v59 offset0:192 offset1:193
    ds_read2_b32 v[66:67], v59 offset0:194 offset1:195
    v_mfma_f32_16x16x32_bf16 v[140:143], v[80:83], v[116:119], v[140:143]
    ds_read2_b32 v[68:69], v59 offset0:200 offset1:201
    ds_read2_b32 v[70:71], v59 offset0:202 offset1:203
    v_mfma_f32_16x16x32_bf16 v[148:151], v[84:87], v[116:119], v[148:151]
    v_mfma_f32_16x16x32_bf16 v[156:159], v[88:91], v[116:119], v[156:159]
    v_mfma_f32_16x16x32_bf16 v[164:167], v[92:95], v[116:119], v[164:167]
    s_waitcnt lgkmcnt(0)
    v_mfma_f32_16x16x32_bf16 v[140:143], v[88:91], v[124:127], v[140:143]
    ds_read_b128 v[108:111], v61 offset:160
    ds_read_b128 v[116:119], v61 offset:224
    v_mfma_f32_16x16x32_bf16 v[148:151], v[92:95], v[124:127], v[148:151]
    ds_read2_b32 v[72:73], v59 offset0:208 offset1:209
    ds_read2_b32 v[74:75], v59 offset0:210 offset1:211
    v_mfma_f32_16x16x32_bf16 v[156:159], v[96:99], v[124:127], v[156:159]
    ds_read2_b32 v[76:77], v59 offset0:216 offset1:217
    ds_read2_b32 v[78:79], v59 offset0:218 offset1:219
    v_mfma_f32_16x16x32_bf16 v[164:167], v[100:103], v[124:127], v[164:167]
    ds_read2_b32 v[80:81], v59 offset0:224 offset1:225
    ds_read2_b32 v[82:83], v59 offset0:226 offset1:227
    v_mfma_f32_16x16x32_bf16 v[140:143], v[96:99], v[132:135], v[140:143]
    ds_read2_b32 v[84:85], v59 offset0:232 offset1:233
    ds_read2_b32 v[86:87], v59 offset0:234 offset1:235
    v_mfma_f32_16x16x32_bf16 v[148:151], v[100:103], v[132:135], v[148:151]
    v_mfma_f32_16x16x32_bf16 v[156:159], v[64:67], v[132:135], v[156:159]
    v_mfma_f32_16x16x32_bf16 v[164:167], v[68:71], v[132:135], v[164:167]
    s_waitcnt lgkmcnt(0)
    v_mfma_f32_16x16x32_bf16 v[140:143], v[64:67], v[108:111], v[140:143]
    ds_read_b128 v[124:127], v61 offset:0
    ds_read_b128 v[132:135], v61 offset:64
    v_mfma_f32_16x16x32_bf16 v[148:151], v[68:71], v[108:111], v[148:151]
    ds_read2_b32 v[88:89], v59 offset0:240 offset1:241
    ds_read2_b32 v[90:91], v59 offset0:242 offset1:243
    v_mfma_f32_16x16x32_bf16 v[156:159], v[72:75], v[108:111], v[156:159]
    ds_read2_b32 v[92:93], v59 offset0:248 offset1:249
    ds_read2_b32 v[94:95], v59 offset0:250 offset1:251
    v_mfma_f32_16x16x32_bf16 v[164:167], v[76:79], v[108:111], v[164:167]
    ds_read2_b32 v[96:97], v60 offset0:0 offset1:1
    ds_read2_b32 v[98:99], v60 offset0:2 offset1:3
    v_mfma_f32_16x16x32_bf16 v[140:143], v[72:75], v[116:119], v[140:143]
    ds_read2_b32 v[100:101], v60 offset0:8 offset1:9
    ds_read2_b32 v[102:103], v60 offset0:10 offset1:11
    v_mfma_f32_16x16x32_bf16 v[148:151], v[76:79], v[116:119], v[148:151]
    v_mfma_f32_16x16x32_bf16 v[156:159], v[80:83], v[116:119], v[156:159]
    v_mfma_f32_16x16x32_bf16 v[164:167], v[84:87], v[116:119], v[164:167]
    s_waitcnt lgkmcnt(0)
    v_mfma_f32_16x16x32_bf16 v[140:143], v[80:83], v[124:127], v[140:143]
    v_mfma_f32_16x16x32_bf16 v[148:151], v[84:87], v[124:127], v[148:151]
    v_mfma_f32_16x16x32_bf16 v[156:159], v[88:91], v[124:127], v[156:159]
    v_mfma_f32_16x16x32_bf16 v[164:167], v[92:95], v[124:127], v[164:167]
    v_mfma_f32_16x16x32_bf16 v[140:143], v[88:91], v[132:135], v[140:143]
    v_mfma_f32_16x16x32_bf16 v[148:151], v[92:95], v[132:135], v[148:151]
    v_mfma_f32_16x16x32_bf16 v[156:159], v[96:99], v[132:135], v[156:159]
    v_mfma_f32_16x16x32_bf16 v[164:167], v[100:103], v[132:135], v[164:167]
K2_EPI:
    s_nop 7
    ds_write_b128 v62, v[136:139] offset:0
    ds_write_b128 v62, v[140:143] offset:4352
    ds_write_b128 v62, v[144:147] offset:64
    ds_write_b128 v62, v[148:151] offset:4416
    ds_write_b128 v62, v[152:155] offset:128
    ds_write_b128 v62, v[156:159] offset:4480
    ds_write_b128 v62, v[160:163] offset:192
    ds_write_b128 v62, v[164:167] offset:4544
    v_lshrrev_b32 v16, 4, v0
    v_mul_u32_u24 v18, 57344, v16
    v_mul_u32_u24 v16, 272, v16
    v_and_b32 v17, 15, v0
    v_lshl_add_u32 v16, v17, 4, v16
    v_add_u32 v16, 17408, v16
    v_add_u32 v19, 34816, v16
    s_and_b32 s6, s58, 1
    s_lshl_b32 s6, s6, 2
    s_bfe_u32 s7, s58, 0x10002
    s_lshl_b32 s7, s7, 3
    s_or_b32 s6, s6, s7
    v_xor_b32 v17, s6, v17
    v_lshl_add_u32 v18, v17, 3, v18
    s_lshl_b32 s6, s58, 8
    s_add_u32 s6, s6, 4194304
    v_add_u32 v18, s6, v18
    s_waitcnt lgkmcnt(0)
    s_barrier
    ds_read_b128 v[64:67], v16 offset:0
    ds_read_b128 v[68:71], v16 offset:8704
    ds_read_b128 v[72:75], v16 offset:17408
    ds_read_b128 v[76:79], v16 offset:26112
    ds_read_b128 v[80:83], v19 offset:0
    ds_read_b128 v[84:87], v19 offset:8704
    ds_read_b128 v[88:91], v19 offset:17408
    ds_read_b128 v[92:95], v19 offset:26112
    s_waitcnt lgkmcnt(0)
    v_pk_add_f32 v[64:65], v[64:65], v[68:69]
    v_pk_add_f32 v[72:73], v[72:73], v[76:77]
    v_pk_add_f32 v[64:65], v[64:65], v[72:73]
    v_cvt_pk_bf16_f32 v40, v64, v65
    v_lshlrev_b32 v42, 16, v44
    v_and_b32 v43, s15, v44
    v_mul_f32 v42, s12, v42
    v_mul_f32 v43, s12, v43
    v_cvt_pk_bf16_f32 v42, v42, v43
    v_lshlrev_b32 v41, 16, v40
    v_and_b32 v40, s15, v40
    v_lshlrev_b32 v43, 16, v42
    v_and_b32 v42, s15, v42
    v_add_f32 v41, v41, v43
    v_add_f32 v40, v40, v42
    v_cvt_pk_bf16_f32 v40, v41, v40
    v_lshlrev_b32 v41, 16, v40
    v_and_b32 v40, s15, v40
    v_lshlrev_b32 v42, 16, v248
    v_lshlrev_b32 v43, 16, v249
    v_add_f32 v41, v41, v42
    v_add_f32 v40, v40, v43
    v_cvt_pk_bf16_f32 v96, v41, v40
    v_pk_add_f32 v[66:67], v[66:67], v[70:71]
    v_pk_add_f32 v[74:75], v[74:75], v[78:79]
    v_pk_add_f32 v[66:67], v[66:67], v[74:75]
    v_cvt_pk_bf16_f32 v40, v66, v67
    v_lshlrev_b32 v42, 16, v45
    v_and_b32 v43, s15, v45
    v_mul_f32 v42, s12, v42
    v_mul_f32 v43, s12, v43
    v_cvt_pk_bf16_f32 v42, v42, v43
    v_lshlrev_b32 v41, 16, v40
    v_and_b32 v40, s15, v40
    v_lshlrev_b32 v43, 16, v42
    v_and_b32 v42, s15, v42
    v_add_f32 v41, v41, v43
    v_add_f32 v40, v40, v42
    v_cvt_pk_bf16_f32 v40, v41, v40
    v_lshlrev_b32 v41, 16, v40
    v_and_b32 v40, s15, v40
    v_lshlrev_b32 v42, 16, v250
    v_lshlrev_b32 v43, 16, v251
    v_add_f32 v41, v41, v42
    v_add_f32 v40, v40, v43
    v_cvt_pk_bf16_f32 v97, v41, v40
    global_store_dwordx2 v18, v[96:97], s[32:33] offset:0 sc1
    v_pk_add_f32 v[80:81], v[80:81], v[84:85]
    v_pk_add_f32 v[88:89], v[88:89], v[92:93]
    v_pk_add_f32 v[80:81], v[80:81], v[88:89]
    v_cvt_pk_bf16_f32 v40, v80, v81
    v_lshlrev_b32 v42, 16, v46
    v_and_b32 v43, s15, v46
    v_mul_f32 v42, s13, v42
    v_mul_f32 v43, s13, v43
    v_cvt_pk_bf16_f32 v42, v42, v43
    v_lshlrev_b32 v41, 16, v40
    v_and_b32 v40, s15, v40
    v_lshlrev_b32 v43, 16, v42
    v_and_b32 v42, s15, v42
    v_add_f32 v41, v41, v43
    v_add_f32 v40, v40, v42
    v_cvt_pk_bf16_f32 v40, v41, v40
    v_lshlrev_b32 v41, 16, v40
    v_and_b32 v40, s15, v40
    v_and_b32 v42, s15, v248
    v_and_b32 v43, s15, v249
    v_add_f32 v41, v41, v42
    v_add_f32 v40, v40, v43
    v_cvt_pk_bf16_f32 v98, v41, v40
    v_pk_add_f32 v[82:83], v[82:83], v[86:87]
    v_pk_add_f32 v[90:91], v[90:91], v[94:95]
    v_pk_add_f32 v[82:83], v[82:83], v[90:91]
    v_cvt_pk_bf16_f32 v40, v82, v83
    v_lshlrev_b32 v42, 16, v47
    v_and_b32 v43, s15, v47
    v_mul_f32 v42, s13, v42
    v_mul_f32 v43, s13, v43
    v_cvt_pk_bf16_f32 v42, v42, v43
    v_lshlrev_b32 v41, 16, v40
    v_and_b32 v40, s15, v40
    v_lshlrev_b32 v43, 16, v42
    v_and_b32 v42, s15, v42
    v_add_f32 v41, v41, v43
    v_add_f32 v40, v40, v42
    v_cvt_pk_bf16_f32 v40, v41, v40
    v_lshlrev_b32 v41, 16, v40
    v_and_b32 v40, s15, v40
    v_and_b32 v42, s15, v250
    v_and_b32 v43, s15, v251
    v_add_f32 v41, v41, v42
    v_add_f32 v40, v40, v43
    v_cvt_pk_bf16_f32 v99, v41, v40
    global_store_dwordx2 v18, v[98:99], s[32:33] offset:128 sc1
    s_endpgm
K1_LN:
    s_getpc_b64 s[6:7]
K1_PC0:
    s_sub_u32 s6, s6, K1_PC0-k1_kernel
    s_subb_u32 s7, s7, 0
    v_lshlrev_b32 v1, 4, v0
    v_min_u32 v212, K1_PC0-k1_kernel-16, v1
    global_load_dwordx4 v[200:203], v212, s[6:7]
    v_add_u32 v1, 8192, v1
    v_min_u32 v212, K1_PC0-k1_kernel-16, v1
    global_load_dwordx4 v[204:207], v212, s[6:7]
    v_add_u32 v1, 8192, v1
    v_min_u32 v212, K1_PC0-k1_kernel-16, v1
    global_load_dwordx4 v[208:211], v212, s[6:7]
    s_lshl_b32 s4, s2, 6
    s_and_b32 s5, s3, 3
    s_lshl_b32 s5, s5, 4
    s_add_u32 s4, s4, s5
    s_lshr_b32 s6, s3, 2
    v_and_b32 v3, 15, v2
    v_lshrrev_b32 v4, 4, v2
    v_add_u32 v5, s4, v3
    v_mul_u32_u24 v6, 896, v5
    v_lshl_add_u32 v6, v4, 4, v6
    s_mul_i32 s7, s6, 448
    v_add_u32 v6, s7, v6
    s_mov_b32 s15, 0xffff0000
    s_waitcnt lgkmcnt(0)
    global_load_dwordx4 v[8:11], v6, s[16:17] offset:0
    global_load_dwordx4 v[12:15], v6, s[16:17] offset:64
    global_load_dwordx4 v[16:19], v6, s[16:17] offset:128
    global_load_dwordx4 v[20:23], v6, s[16:17] offset:192
    global_load_dwordx4 v[24:27], v6, s[16:17] offset:256
    global_load_dwordx4 v[28:31], v6, s[16:17] offset:320
    global_load_dwordx4 v[32:35], v6, s[16:17] offset:384
    s_lshl_b32 s7, s3, 6
    v_lshl_add_u32 v250, v3, 2, s7
    v_xor_b32 v251, 256, v250
    s_waitcnt vmcnt(0)
    v_lshlrev_b32 v64, 16, v8
    v_and_b32 v65, s15, v8
    v_pk_add_f32 v[240:241], v[64:65], 0
    v_lshlrev_b32 v66, 16, v9
    v_and_b32 v67, s15, v9
    v_pk_add_f32 v[240:241], v[240:241], v[66:67]
    v_lshlrev_b32 v68, 16, v10
    v_and_b32 v69, s15, v10
    v_pk_add_f32 v[240:241], v[240:241], v[68:69]
    v_lshlrev_b32 v70, 16, v11
    v_and_b32 v71, s15, v11
    v_pk_add_f32 v[240:241], v[240:241], v[70:71]
    v_lshlrev_b32 v72, 16, v12
    v_and_b32 v73, s15, v12
    v_pk_add_f32 v[240:241], v[240:241], v[72:73]
    v_lshlrev_b32 v74, 16, v13
    v_and_b32 v75, s15, v13
    v_pk_add_f32 v[240:241], v[240:241], v[74:75]
    v_lshlrev_b32 v76, 16, v14
    v_and_b32 v77, s15, v14
    v_pk_add_f32 v[240:241], v[240:241], v[76:77]
    v_lshlrev_b32 v78, 16, v15
    v_and_b32 v79, s15, v15
    v_pk_add_f32 v[240:241], v[240:241], v[78:79]
    v_lshlrev_b32 v80, 16, v16
    v_and_b32 v81, s15, v16
    v_pk_add_f32 v[240:241], v[240:241], v[80:81]
    v_lshlrev_b32 v82, 16, v17
    v_and_b32 v83, s15, v17
    v_pk_add_f32 v[240:241], v[240:241], v[82:83]
    v_lshlrev_b32 v84, 16, v18
    v_and_b32 v85, s15, v18
    v_pk_add_f32 v[240:241], v[240:241], v[84:85]
    v_lshlrev_b32 v86, 16, v19
    v_and_b32 v87, s15, v19
    v_pk_add_f32 v[240:241], v[240:241], v[86:87]
    v_lshlrev_b32 v88, 16, v20
    v_and_b32 v89, s15, v20
    v_pk_add_f32 v[240:241], v[240:241], v[88:89]
    v_lshlrev_b32 v90, 16, v21
    v_and_b32 v91, s15, v21
    v_pk_add_f32 v[240:241], v[240:241], v[90:91]
    v_lshlrev_b32 v92, 16, v22
    v_and_b32 v93, s15, v22
    v_pk_add_f32 v[240:241], v[240:241], v[92:93]
    v_lshlrev_b32 v94, 16, v23
    v_and_b32 v95, s15, v23
    v_pk_add_f32 v[240:241], v[240:241], v[94:95]
    v_lshlrev_b32 v96, 16, v24
    v_and_b32 v97, s15, v24
    v_pk_add_f32 v[240:241], v[240:241], v[96:97]
    v_lshlrev_b32 v98, 16, v25
    v_and_b32 v99, s15, v25
    v_pk_add_f32 v[240:241], v[240:241], v[98:99]
    v_lshlrev_b32 v100, 16, v26
    v_and_b32 v101, s15, v26
    v_pk_add_f32 v[240:241], v[240:241], v[100:101]
    v_lshlrev_b32 v102, 16, v27
    v_and_b32 v103, s15, v27
    v_pk_add_f32 v[240:241], v[240:241], v[102:103]
    v_lshlrev_b32 v104, 16, v28
    v_and_b32 v105, s15, v28
    v_pk_add_f32 v[240:241], v[240:241], v[104:105]
    v_lshlrev_b32 v106, 16, v29
    v_and_b32 v107, s15, v29
    v_pk_add_f32 v[240:241], v[240:241], v[106:107]
    v_lshlrev_b32 v108, 16, v30
    v_and_b32 v109, s15, v30
    v_pk_add_f32 v[240:241], v[240:241], v[108:109]
    v_lshlrev_b32 v110, 16, v31
    v_and_b32 v111, s15, v31
    v_pk_add_f32 v[240:241], v[240:241], v[110:111]
    v_lshlrev_b32 v112, 16, v32
    v_and_b32 v113, s15, v32
    v_pk_add_f32 v[240:241], v[240:241], v[112:113]
    v_lshlrev_b32 v114, 16, v33
    v_and_b32 v115, s15, v33
    v_pk_add_f32 v[240:241], v[240:241], v[114:115]
    v_lshlrev_b32 v116, 16, v34
    v_and_b32 v117, s15, v34
    v_pk_add_f32 v[240:241], v[240:241], v[116:117]
    v_lshlrev_b32 v118, 16, v35
    v_and_b32 v119, s15, v35
    v_pk_add_f32 v[240:241], v[240:241], v[118:119]
    v_add_f32 v240, v240, v241
    v_mov_b32 v244, v240
    s_nop 1
    v_permlane16_swap_b32 v240, v244
    v_add_f32 v240, v240, v244
    v_mov_b32 v244, v240
    s_nop 1
    v_permlane32_swap_b32 v240, v244
    v_add_f32 v240, v240, v244
    ds_write_b32 v250, v240
    s_waitcnt lgkmcnt(0)
    s_barrier
    ds_read_b32 v244, v251
    s_waitcnt lgkmcnt(0)
    v_add_f32 v240, v240, v244
    v_mul_f32 v246, 0x3b124925, v240
    v_mov_b32 v247, v246
    v_pk_add_f32 v[244:245], v[64:65], v[246:247] neg_lo:[0,1] neg_hi:[0,1]
    v_pk_mul_f32 v[242:243], v[244:245], v[244:245]
    v_pk_add_f32 v[252:253], v[66:67], v[246:247] neg_lo:[0,1] neg_hi:[0,1]
    v_pk_fma_f32 v[242:243], v[252:253], v[252:253], v[242:243]
    v_pk_add_f32 v[244:245], v[68:69], v[246:247] neg_lo:[0,1] neg_hi:[0,1]
    v_pk_fma_f32 v[242:243], v[244:245], v[244:245], v[242:243]
    v_pk_add_f32 v[252:253], v[70:71], v[246:247] neg_lo:[0,1] neg_hi:[0,1]
    v_pk_fma_f32 v[242:243], v[252:253], v[252:253], v[242:243]
    v_pk_add_f32 v[244:245], v[72:73], v[246:247] neg_lo:[0,1] neg_hi:[0,1]
    v_pk_fma_f32 v[242:243], v[244:245], v[244:245], v[242:243]
    v_pk_add_f32 v[252:253], v[74:75], v[246:247] neg_lo:[0,1] neg_hi:[0,1]
    v_pk_fma_f32 v[242:243], v[252:253], v[252:253], v[242:243]
    v_pk_add_f32 v[244:245], v[76:77], v[246:247] neg_lo:[0,1] neg_hi:[0,1]
    v_pk_fma_f32 v[242:243], v[244:245], v[244:245], v[242:243]
    v_pk_add_f32 v[252:253], v[78:79], v[246:247] neg_lo:[0,1] neg_hi:[0,1]
    v_pk_fma_f32 v[242:243], v[252:253], v[252:253], v[242:243]
    v_pk_add_f32 v[244:245], v[80:81], v[246:247] neg_lo:[0,1] neg_hi:[0,1]
    v_pk_fma_f32 v[242:243], v[244:245], v[244:245], v[242:243]
    v_pk_add_f32 v[252:253], v[82:83], v[246:247] neg_lo:[0,1] neg_hi:[0,1]
    v_pk_fma_f32 v[242:243], v[252:253], v[252:253], v[242:243]
    v_pk_add_f32 v[244:245], v[84:85], v[246:247] neg_lo:[0,1] neg_hi:[0,1]
    v_pk_fma_f32 v[242:243], v[244:245], v[244:245], v[242:243]
    v_pk_add_f32 v[252:253], v[86:87], v[246:247] neg_lo:[0,1] neg_hi:[0,1]
    v_pk_fma_f32 v[242:243], v[252:253], v[252:253], v[242:243]
    v_pk_add_f32 v[244:245], v[88:89], v[246:247] neg_lo:[0,1] neg_hi:[0,1]
    v_pk_fma_f32 v[242:243], v[244:245], v[244:245], v[242:243]
    v_pk_add_f32 v[252:253], v[90:91], v[246:247] neg_lo:[0,1] neg_hi:[0,1]
    v_pk_fma_f32 v[242:243], v[252:253], v[252:253], v[242:243]
    v_pk_add_f32 v[244:245], v[92:93], v[246:247] neg_lo:[0,1] neg_hi:[0,1]
    v_pk_fma_f32 v[242:243], v[244:245], v[244:245], v[242:243]
    v_pk_add_f32 v[252:253], v[94:95], v[246:247] neg_lo:[0,1] neg_hi:[0,1]
    v_pk_fma_f32 v[242:243], v[252:253], v[252:253], v[242:243]
    v_pk_add_f32 v[244:245], v[96:97], v[246:247] neg_lo:[0,1] neg_hi:[0,1]
    v_pk_fma_f32 v[242:243], v[244:245], v[244:245], v[242:243]
    v_pk_add_f32 v[252:253], v[98:99], v[246:247] neg_lo:[0,1] neg_hi:[0,1]
    v_pk_fma_f32 v[242:243], v[252:253], v[252:253], v[242:243]
    v_pk_add_f32 v[244:245], v[100:101], v[246:247] neg_lo:[0,1] neg_hi:[0,1]
    v_pk_fma_f32 v[242:243], v[244:245], v[244:245], v[242:243]
    v_pk_add_f32 v[252:253], v[102:103], v[246:247] neg_lo:[0,1] neg_hi:[0,1]
    v_pk_fma_f32 v[242:243], v[252:253], v[252:253], v[242:243]
    v_pk_add_f32 v[244:245], v[104:105], v[246:247] neg_lo:[0,1] neg_hi:[0,1]
    v_pk_fma_f32 v[242:243], v[244:245], v[244:245], v[242:243]
    v_pk_add_f32 v[252:253], v[106:107], v[246:247] neg_lo:[0,1] neg_hi:[0,1]
    v_pk_fma_f32 v[242:243], v[252:253], v[252:253], v[242:243]
    v_pk_add_f32 v[244:245], v[108:109], v[246:247] neg_lo:[0,1] neg_hi:[0,1]
    v_pk_fma_f32 v[242:243], v[244:245], v[244:245], v[242:243]
    v_pk_add_f32 v[252:253], v[110:111], v[246:247] neg_lo:[0,1] neg_hi:[0,1]
    v_pk_fma_f32 v[242:243], v[252:253], v[252:253], v[242:243]
    v_pk_add_f32 v[244:245], v[112:113], v[246:247] neg_lo:[0,1] neg_hi:[0,1]
    v_pk_fma_f32 v[242:243], v[244:245], v[244:245], v[242:243]
    v_pk_add_f32 v[252:253], v[114:115], v[246:247] neg_lo:[0,1] neg_hi:[0,1]
    v_pk_fma_f32 v[242:243], v[252:253], v[252:253], v[242:243]
    v_pk_add_f32 v[244:245], v[116:117], v[246:247] neg_lo:[0,1] neg_hi:[0,1]
    v_pk_fma_f32 v[242:243], v[244:245], v[244:245], v[242:243]
    v_pk_add_f32 v[252:253], v[118:119], v[246:247] neg_lo:[0,1] neg_hi:[0,1]
    v_pk_fma_f32 v[242:243], v[252:253], v[252:253], v[242:243]
    v_add_f32 v242, v242, v243
    v_mov_b32 v244, v242
    s_nop 1
    v_permlane16_swap_b32 v242, v244
    v_add_f32 v242, v242, v244
    v_mov_b32 v244, v242
    s_nop 1
    v_permlane32_swap_b32 v242, v244
    v_add_f32 v242, v242, v244
    ds_write_b32 v250, v242 offset:512
    s_waitcnt lgkmcnt(0)
    s_barrier
    ds_read_b32 v244, v251 offset:512
    s_waitcnt lgkmcnt(0)
    v_add_f32 v242, v242, v244
    s_cmp_ge_u32 s3, 4
    s_cbranch_scc1 K1_LNE
    v_mul_f32 v242, 0x3b124925, v242
    v_cvt_pk_bf16_f32 v244, v246, v242
    v_lshlrev_b32 v248, 16, v244
    v_and_b32 v244, s15, v244
    v_add_f32 v244, 0x3727c5ac, v244
    v_cvt_pk_bf16_f32 v244, v244, v244
    v_and_b32 v244, s15, v244
    v_sqrt_f32 v244, v244
    s_nop 0
    v_cvt_pk_bf16_f32 v244, v244, v244
    v_and_b32 v244, s15, v244
    v_rcp_f32 v249, v244
    v_lshlrev_b32 v245, 3, v5
    v_add_u32 v245, 2097152, v245
    s_mov_b64 exec, 0xffff
    global_store_dwordx2 v245, v[248:249], s[32:33] sc1
    s_mov_b64 exec, -1
K1_LNE:
    s_waitcnt vmcnt(0)
    s_barrier
    s_cmp_lg_u32 s3, 0
    s_cbranch_scc1 K1_LNX
    v_mov_b32 v1, 0
    v_mov_b32 v2, 1
    s_mov_b64 exec, 1
    global_atomic_add v3, v1, v2, s[34:35] sc0 sc1
    s_waitcnt vmcnt(0)
    v_readfirstlane_b32 s6, v3
    s_cmp_lg_u32 s6, 31
    s_cbranch_scc1 K1_LNY
    global_store_dword v1, v2, s[34:35] offset:128 sc1
K1_LNY:
    s_mov_b64 exec, -1
K1_LNX:
    s_getpc_b64 s[6:7]
K1_PC:
    s_add_u32 s6, s6, k3_kernel-K1_PC
    s_addc_u32 s7, s7, 0
    v_lshlrev_b32 v1, 4, v0
    v_min_u32 v3, K4_END-k3_kernel-16, v1
    global_load_dwordx4 v[8:11], v3, s[6:7]
    v_add_u32 v1, 8192, v1
    v_min_u32 v3, K4_END-k3_kernel-16, v1
    global_load_dwordx4 v[12:15], v3, s[6:7]
    v_add_u32 v1, 8192, v1
    v_min_u32 v3, K4_END-k3_kernel-16, v1
    global_load_dwordx4 v[16:19], v3, s[6:7]
K1_END:
    s_endpgm
.section .rodata,"a"
.p2align 6
.amdhsa_kernel k1_kernel
  .amdhsa_next_free_vgpr 256
  .amdhsa_next_free_sgpr 62
  .amdhsa_accum_offset 256
  .amdhsa_group_segment_fixed_size 0
  .amdhsa_kernarg_size 120
  .amdhsa_user_sgpr_count 2
  .amdhsa_user_sgpr_kernarg_segment_ptr 1
  .amdhsa_system_sgpr_workgroup_id_x 1
.end_amdhsa_kernel
.text
.globl k3_kernel
.p2align 8
.type k3_kernel,@function
k3_kernel:

    s_cmp_ge_u32 s2, 256
    s_cbranch_scc1 K3_END
    s_load_dwordx2 s[32:33], s[0:1], 112
    v_lshrrev_b32 v1, 6, v0
    v_and_b32 v2, 63, v0
    v_readfirstlane_b32 s3, v1
    s_mov_b32 s15, 0xffff0000
    s_cmp_ge_u32 s2, 224
    s_cbranch_scc1 K3_PF
    s_and_b32 s4, s2, 7
    s_lshr_b32 s6, s2, 3
    s_mul_i32 s7, s6, 37
    s_lshr_b32 s7, s7, 8
    s_mul_i32 s8, s7, 7
    s_sub_u32 s5, s6, s8
    s_lshl_b32 s4, s4, 2
    s_add_u32 s4, s4, s7
    v_and_b32 v3, 15, v2
    v_lshrrev_b32 v4, 4, v2
    v_lshlrev_b32 v7, 4, v2
    s_mul_i32 s7, s4, 57344
    s_mul_i32 s8, s3, 7168
    s_add_u32 s7, s7, s8
    s_add_u32 s7, s7, 4194304
    v_add_u32 v5, s7, v7
    s_lshl_b32 s7, s5, 4
    s_lshl_b32 s9, s3, 1
    s_add_u32 s7, s7, s9
    s_mul_i32 s7, s7, 14336
    s_add_u32 s7, s7, 16777216
    v_add_u32 v208, s7, v7
    v_add_u32 v209, 14336, v208
    v_add_u32 v214, 57344, v7
    s_lshl_b32 s7, s4, 2
    s_mul_i32 s7, s7, 56
    s_lshl_b32 s9, s5, 3
    s_add_u32 s7, s7, s9
    s_add_u32 s7, s7, s3
    s_lshl_b32 s7, s7, 10
    s_add_u32 s7, s7, 8388608
    v_add_u32 v6, s7, v7
    s_waitcnt lgkmcnt(0)
    s_mov_b32 s36, s32
    s_mov_b32 s37, s33
    s_mov_b32 s38, 6029312
    s_mov_b32 s39, 0x00020000
    s_add_u32 m0, s8, 0
    s_mov_b32 s14, 0
    buffer_load_dwordx4 v5, s[36:39], s14 offen offset:0 lds
    buffer_load_dwordx4 v5, s[36:39], s14 offen offset:1024 lds
    buffer_load_dwordx4 v5, s[36:39], s14 offen offset:2048 lds
    buffer_load_dwordx4 v5, s[36:39], s14 offen offset:3072 lds
    s_add_u32 m0, s8, 4096
    s_mov_b32 s14, 4096
    buffer_load_dwordx4 v5, s[36:39], s14 offen offset:0 lds
    buffer_load_dwordx4 v5, s[36:39], s14 offen offset:1024 lds
    buffer_load_dwordx4 v5, s[36:39], s14 offen offset:2048 lds
    s_cmp_lt_u32 s3, 4
    s_cbranch_scc1 K3_LN
    global_load_dwordx4 v[40:43], v208, s[32:33] offset:0
    global_load_dwordx4 v[44:47], v209, s[32:33] offset:0
    global_load_dwordx4 v[48:51], v208, s[32:33] offset:1024
    global_load_dwordx4 v[52:55], v209, s[32:33] offset:1024
    global_load_dwordx4 v[56:59], v208, s[32:33] offset:2048
    global_load_dwordx4 v[60:63], v209, s[32:33] offset:2048
    global_load_dwordx4 v[64:67], v208, s[32:33] offset:3072
    global_load_dwordx4 v[68:71], v209, s[32:33] offset:3072
    s_waitcnt vmcnt(8)
    s_barrier
    v_add_u32 v208, 4096, v208
    global_load_dwordx4 v[72:75], v208, s[32:33] offset:0
    v_add_u32 v209, 4096, v209
    global_load_dwordx4 v[76:79], v209, s[32:33] offset:0
    global_load_dwordx4 v[80:83], v208, s[32:33] offset:1024
    global_load_dwordx4 v[84:87], v209, s[32:33] offset:1024
    global_load_dwordx4 v[88:91], v208, s[32:33] offset:2048
    global_load_dwordx4 v[92:95], v209, s[32:33] offset:2048
    global_load_dwordx4 v[96:99], v208, s[32:33] offset:3072
    global_load_dwordx4 v[100:103], v209, s[32:33] offset:3072
    v_add_u32 v208, 4096, v208
    global_load_dwordx4 v[104:107], v208, s[32:33] offset:0
    v_add_u32 v209, 4096, v209
    global_load_dwordx4 v[108:111], v209, s[32:33] offset:0
    global_load_dwordx4 v[112:115], v208, s[32:33] offset:1024
    global_load_dwordx4 v[116:119], v209, s[32:33] offset:1024
    global_load_dwordx4 v[120:123], v208, s[32:33] offset:2048
    global_load_dwordx4 v[124:127], v209, s[32:33] offset:2048
    global_load_dwordx4 v[128:131], v208, s[32:33] offset:3072
    global_load_dwordx4 v[132:135], v209, s[32:33] offset:3072
    v_add_u32 v208, 4096, v208
    global_load_dwordx4 v[136:139], v208, s[32:33] offset:0
    v_add_u32 v209, 4096, v209
    global_load_dwordx4 v[140:143], v209, s[32:33] offset:0
    global_load_dwordx4 v[144:147], v208, s[32:33] offset:1024
    global_load_dwordx4 v[148:151], v209, s[32:33] offset:1024
    s_branch K3_MAIN
K3_LN:
    s_lshl_b32 s6, s4, 6
    s_lshl_b32 s7, s3, 4
    s_add_u32 s6, s6, s7
    v_lshrrev_b32 v192, 2, v3
    v_lshlrev_b32 v193, 3, v192
    v_and_b32 v194, 3, v3
    v_add_u32 v193, v193, v194
    v_lshrrev_b32 v194, 1, v4
    v_lshl_add_u32 v193, v194, 2, v193
    v_lshlrev_b32 v193, 7, v193
    v_and_b32 v192, 1, v192
    v_lshlrev_b32 v192, 2, v192
    v_bfe_u32 v194, v3, 1, 1
    v_lshl_add_u32 v192, v194, 1, v192
    s_lshl_b32 s7, s3, 1
    v_and_b32 v194, 1, v4
    v_add_u32 v194, s7, v194
    v_xor_b32 v194, v194, v192
    v_lshl_add_u32 v215, v194, 4, v193
    v_add_u32 v210, s6, v3
    v_mul_u32_u24 v210, 896, v210
    v_lshl_add_u32 v210, v4, 4, v210
    v_add_u32 v210, 6291456, v210
    s_mul_i32 s7, s3, 14336
    s_add_u32 s7, s7, 57344
    v_add_u32 v211, s7, v7
    v_and_b32 v192, 15, v2
    v_lshrrev_b32 v193, 4, v2
    v_lshrrev_b32 v194, 3, v192
    v_sub_u32 v193, v193, v194
    v_and_b32 v194, 1, v192
    v_lshlrev_b32 v194, 4, v194
    v_mov_b32 v184, 0x3f80
    v_lshlrev_b32 v194, v194, v184
    v_bfe_u32 v192, v192, 1, 2
    v_lshlrev_b32 v193, 2, v193
    v_add_u32 v192, v192, v193
    v_cmp_eq_u32 vcc, 0, v192
    s_nop 1
    v_cndmask_b32 v184, 0, v194, vcc
    v_cmp_eq_u32 vcc, 1, v192
    s_nop 1
    v_cndmask_b32 v185, 0, v194, vcc
    v_cmp_eq_u32 vcc, 2, v192
    s_nop 1
    v_cndmask_b32 v186, 0, v194, vcc
    v_cmp_eq_u32 vcc, 3, v192
    s_nop 1
    v_cndmask_b32 v187, 0, v194, vcc
    v_cmp_eq_u32 vcc, 8, v192
    s_nop 1
    v_cndmask_b32 v188, 0, v194, vcc
    v_cmp_eq_u32 vcc, 9, v192
    s_nop 1
    v_cndmask_b32 v189, 0, v194, vcc
    v_cmp_eq_u32 vcc, 10, v192
    s_nop 1
    v_cndmask_b32 v190, 0, v194, vcc
    v_cmp_eq_u32 vcc, 11, v192
    s_nop 1
    v_cndmask_b32 v191, 0, v194, vcc
    s_waitcnt vmcnt(0)
    s_barrier
    ds_read_b128 v[8:11], v215 offset:0
    ds_read_b128 v[12:15], v215 offset:4096
    ds_read_b128 v[16:19], v215 offset:8192
    ds_read_b128 v[20:23], v215 offset:12288
    ds_read_b128 v[24:27], v215 offset:16384
    ds_read_b128 v[28:31], v215 offset:20480
    ds_read_b128 v[32:35], v215 offset:24576
    s_waitcnt lgkmcnt(6)
    v_mfma_f32_16x16x32_bf16 v[40:43], v[8:11], v[184:187], 0
    v_mfma_f32_16x16x32_bf16 v[44:47], v[8:11], v[188:191], 0
    s_waitcnt lgkmcnt(5)
    v_mfma_f32_16x16x32_bf16 v[48:51], v[12:15], v[184:187], 0
    v_mfma_f32_16x16x32_bf16 v[52:55], v[12:15], v[188:191], 0
    s_waitcnt lgkmcnt(4)
    v_mfma_f32_16x16x32_bf16 v[56:59], v[16:19], v[184:187], 0
    v_mfma_f32_16x16x32_bf16 v[60:63], v[16:19], v[188:191], 0
    s_waitcnt lgkmcnt(3)
    v_mfma_f32_16x16x32_bf16 v[64:67], v[20:23], v[184:187], 0
    v_mfma_f32_16x16x32_bf16 v[68:71], v[20:23], v[188:191], 0
    s_waitcnt lgkmcnt(2)
    v_mfma_f32_16x16x32_bf16 v[72:75], v[24:27], v[184:187], 0
    v_mfma_f32_16x16x32_bf16 v[76:79], v[24:27], v[188:191], 0
    s_waitcnt lgkmcnt(1)
    v_mfma_f32_16x16x32_bf16 v[80:83], v[28:31], v[184:187], 0
    v_mfma_f32_16x16x32_bf16 v[84:87], v[28:31], v[188:191], 0
    s_waitcnt lgkmcnt(0)
    v_mfma_f32_16x16x32_bf16 v[88:91], v[32:35], v[184:187], 0
    v_mfma_f32_16x16x32_bf16 v[92:95], v[32:35], v[188:191], 0
    ds_read_b128 v[8:11], v215 offset:28672
    ds_read_b128 v[12:15], v215 offset:32768
    ds_read_b128 v[16:19], v215 offset:36864
    ds_read_b128 v[20:23], v215 offset:40960
    ds_read_b128 v[24:27], v215 offset:45056
    ds_read_b128 v[28:31], v215 offset:49152
    ds_read_b128 v[32:35], v215 offset:53248
    s_waitcnt lgkmcnt(6)
    v_mfma_f32_16x16x32_bf16 v[96:99], v[8:11], v[184:187], 0
    v_mfma_f32_16x16x32_bf16 v[100:103], v[8:11], v[188:191], 0
    s_waitcnt lgkmcnt(5)
    v_mfma_f32_16x16x32_bf16 v[104:107], v[12:15], v[184:187], 0
    v_mfma_f32_16x16x32_bf16 v[108:111], v[12:15], v[188:191], 0
    s_waitcnt lgkmcnt(4)
    v_mfma_f32_16x16x32_bf16 v[112:115], v[16:19], v[184:187], 0
    v_mfma_f32_16x16x32_bf16 v[116:119], v[16:19], v[188:191], 0
    s_waitcnt lgkmcnt(3)
    v_mfma_f32_16x16x32_bf16 v[120:123], v[20:23], v[184:187], 0
    v_mfma_f32_16x16x32_bf16 v[124:127], v[20:23], v[188:191], 0
    s_waitcnt lgkmcnt(2)
    v_mfma_f32_16x16x32_bf16 v[128:131], v[24:27], v[184:187], 0
    v_mfma_f32_16x16x32_bf16 v[132:135], v[24:27], v[188:191], 0
    s_waitcnt lgkmcnt(1)
    v_mfma_f32_16x16x32_bf16 v[136:139], v[28:31], v[184:187], 0
    v_mfma_f32_16x16x32_bf16 v[140:143], v[28:31], v[188:191], 0
    s_waitcnt lgkmcnt(0)
    v_mfma_f32_16x16x32_bf16 v[144:147], v[32:35], v[184:187], 0
    v_mfma_f32_16x16x32_bf16 v[148:151], v[32:35], v[188:191], 0
    v_pk_add_f32 v[192:193], v[40:41], 0
    v_pk_add_f32 v[192:193], v[192:193], v[42:43]
    v_pk_add_f32 v[192:193], v[192:193], v[44:45]
    v_pk_add_f32 v[192:193], v[192:193], v[46:47]
    v_pk_add_f32 v[192:193], v[192:193], v[48:49]
    v_pk_add_f32 v[192:193], v[192:193], v[50:51]
    v_pk_add_f32 v[192:193], v[192:193], v[52:53]
    v_pk_add_f32 v[192:193], v[192:193], v[54:55]
    v_pk_add_f32 v[192:193], v[192:193], v[56:57]
    v_pk_add_f32 v[192:193], v[192:193], v[58:59]
    v_pk_add_f32 v[192:193], v[192:193], v[60:61]
    v_pk_add_f32 v[192:193], v[192:193], v[62:63]
    v_pk_add_f32 v[192:193], v[192:193], v[64:65]
    v_pk_add_f32 v[192:193], v[192:193], v[66:67]
    v_pk_add_f32 v[192:193], v[192:193], v[68:69]
    v_pk_add_f32 v[192:193], v[192:193], v[70:71]
    v_pk_add_f32 v[192:193], v[192:193], v[72:73]
    v_pk_add_f32 v[192:193], v[192:193], v[74:75]
    v_pk_add_f32 v[192:193], v[192:193], v[76:77]
    v_pk_add_f32 v[192:193], v[192:193], v[78:79]
    v_pk_add_f32 v[192:193], v[192:193], v[80:81]
    v_pk_add_f32 v[192:193], v[192:193], v[82:83]
    v_pk_add_f32 v[192:193], v[192:193], v[84:85]
    v_pk_add_f32 v[192:193], v[192:193], v[86:87]
    v_pk_add_f32 v[192:193], v[192:193], v[88:89]
    v_pk_add_f32 v[192:193], v[192:193], v[90:91]
    v_pk_add_f32 v[192:193], v[192:193], v[92:93]
    v_pk_add_f32 v[192:193], v[192:193], v[94:95]
    v_pk_add_f32 v[192:193], v[192:193], v[96:97]
    v_pk_add_f32 v[192:193], v[192:193], v[98:99]
    v_pk_add_f32 v[192:193], v[192:193], v[100:101]
    v_pk_add_f32 v[192:193], v[192:193], v[102:103]
    v_pk_add_f32 v[192:193], v[192:193], v[104:105]
    v_pk_add_f32 v[192:193], v[192:193], v[106:107]
    v_pk_add_f32 v[192:193], v[192:193], v[108:109]
    v_pk_add_f32 v[192:193], v[192:193], v[110:111]
    v_pk_add_f32 v[192:193], v[192:193], v[112:113]
    v_pk_add_f32 v[192:193], v[192:193], v[114:115]
    v_pk_add_f32 v[192:193], v[192:193], v[116:117]
    v_pk_add_f32 v[192:193], v[192:193], v[118:119]
    v_pk_add_f32 v[192:193], v[192:193], v[120:121]
    v_pk_add_f32 v[192:193], v[192:193], v[122:123]
    v_pk_add_f32 v[192:193], v[192:193], v[124:125]
    v_pk_add_f32 v[192:193], v[192:193], v[126:127]
    v_pk_add_f32 v[192:193], v[192:193], v[128:129]
    v_pk_add_f32 v[192:193], v[192:193], v[130:131]
    v_pk_add_f32 v[192:193], v[192:193], v[132:133]
    v_pk_add_f32 v[192:193], v[192:193], v[134:135]
    v_pk_add_f32 v[192:193], v[192:193], v[136:137]
    v_pk_add_f32 v[192:193], v[192:193], v[138:139]
    v_pk_add_f32 v[192:193], v[192:193], v[140:141]
    v_pk_add_f32 v[192:193], v[192:193], v[142:143]
    v_pk_add_f32 v[192:193], v[192:193], v[144:145]
    v_pk_add_f32 v[192:193], v[192:193], v[146:147]
    v_pk_add_f32 v[192:193], v[192:193], v[148:149]
    v_pk_add_f32 v[192:193], v[192:193], v[150:151]
    s_cmp_eq_u32 s5, 0
    s_cbranch_scc0 K3_SK0
    v_cvt_pk_bf16_f32 v8, v40, v41
    v_cvt_pk_bf16_f32 v9, v42, v43
    v_cvt_pk_bf16_f32 v10, v44, v45
    v_cvt_pk_bf16_f32 v11, v46, v47
    global_store_dwordx4 v210, v[8:11], s[32:33] offset:0 sc1
    v_cvt_pk_bf16_f32 v12, v48, v49
    v_cvt_pk_bf16_f32 v13, v50, v51
    v_cvt_pk_bf16_f32 v14, v52, v53
    v_cvt_pk_bf16_f32 v15, v54, v55
    global_store_dwordx4 v210, v[12:15], s[32:33] offset:64 sc1
K3_SK0:
    s_cmp_eq_u32 s5, 1
    s_cbranch_scc0 K3_SK1
    v_cvt_pk_bf16_f32 v8, v56, v57
    v_cvt_pk_bf16_f32 v9, v58, v59
    v_cvt_pk_bf16_f32 v10, v60, v61
    v_cvt_pk_bf16_f32 v11, v62, v63
    global_store_dwordx4 v210, v[8:11], s[32:33] offset:128 sc1
    v_cvt_pk_bf16_f32 v12, v64, v65
    v_cvt_pk_bf16_f32 v13, v66, v67
    v_cvt_pk_bf16_f32 v14, v68, v69
    v_cvt_pk_bf16_f32 v15, v70, v71
    global_store_dwordx4 v210, v[12:15], s[32:33] offset:192 sc1
K3_SK1:
    s_cmp_eq_u32 s5, 2
    s_cbranch_scc0 K3_SK2
    v_cvt_pk_bf16_f32 v8, v72, v73
    v_cvt_pk_bf16_f32 v9, v74, v75
    v_cvt_pk_bf16_f32 v10, v76, v77
    v_cvt_pk_bf16_f32 v11, v78, v79
    global_store_dwordx4 v210, v[8:11], s[32:33] offset:256 sc1
    v_cvt_pk_bf16_f32 v12, v80, v81
    v_cvt_pk_bf16_f32 v13, v82, v83
    v_cvt_pk_bf16_f32 v14, v84, v85
    v_cvt_pk_bf16_f32 v15, v86, v87
    global_store_dwordx4 v210, v[12:15], s[32:33] offset:320 sc1
K3_SK2:
    s_cmp_eq_u32 s5, 3
    s_cbranch_scc0 K3_SK3
    v_cvt_pk_bf16_f32 v8, v88, v89
    v_cvt_pk_bf16_f32 v9, v90, v91
    v_cvt_pk_bf16_f32 v10, v92, v93
    v_cvt_pk_bf16_f32 v11, v94, v95
    global_store_dwordx4 v210, v[8:11], s[32:33] offset:384 sc1
    v_cvt_pk_bf16_f32 v12, v96, v97
    v_cvt_pk_bf16_f32 v13, v98, v99
    v_cvt_pk_bf16_f32 v14, v100, v101
    v_cvt_pk_bf16_f32 v15, v102, v103
    global_store_dwordx4 v210, v[12:15], s[32:33] offset:448 sc1
K3_SK3:
    s_cmp_eq_u32 s5, 4
    s_cbranch_scc0 K3_SK4
    v_cvt_pk_bf16_f32 v8, v104, v105
    v_cvt_pk_bf16_f32 v9, v106, v107
    v_cvt_pk_bf16_f32 v10, v108, v109
    v_cvt_pk_bf16_f32 v11, v110, v111
    global_store_dwordx4 v210, v[8:11], s[32:33] offset:512 sc1
    v_cvt_pk_bf16_f32 v12, v112, v113
    v_cvt_pk_bf16_f32 v13, v114, v115
    v_cvt_pk_bf16_f32 v14, v116, v117
    v_cvt_pk_bf16_f32 v15, v118, v119
    global_store_dwordx4 v210, v[12:15], s[32:33] offset:576 sc1
K3_SK4:
    s_cmp_eq_u32 s5, 5
    s_cbranch_scc0 K3_SK5
    v_cvt_pk_bf16_f32 v8, v120, v121
    v_cvt_pk_bf16_f32 v9, v122, v123
    v_cvt_pk_bf16_f32 v10, v124, v125
    v_cvt_pk_bf16_f32 v11, v126, v127
    global_store_dwordx4 v210, v[8:11], s[32:33] offset:640 sc1
    v_cvt_pk_bf16_f32 v12, v128, v129
    v_cvt_pk_bf16_f32 v13, v130, v131
    v_cvt_pk_bf16_f32 v14, v132, v133
    v_cvt_pk_bf16_f32 v15, v134, v135
    global_store_dwordx4 v210, v[12:15], s[32:33] offset:704 sc1
K3_SK5:
    s_cmp_eq_u32 s5, 6
    s_cbranch_scc0 K3_SK6
    v_cvt_pk_bf16_f32 v8, v136, v137
    v_cvt_pk_bf16_f32 v9, v138, v139
    v_cvt_pk_bf16_f32 v10, v140, v141
    v_cvt_pk_bf16_f32 v11, v142, v143
    global_store_dwordx4 v210, v[8:11], s[32:33] offset:768 sc1
    v_cvt_pk_bf16_f32 v12, v144, v145
    v_cvt_pk_bf16_f32 v13, v146, v147
    v_cvt_pk_bf16_f32 v14, v148, v149
    v_cvt_pk_bf16_f32 v15, v150, v151
    global_store_dwordx4 v210, v[12:15], s[32:33] offset:832 sc1
K3_SK6:
    s_nop 1
    v_add_f32 v192, v192, v193
    v_mov_b32 v196, v192
    s_nop 1
    v_permlane16_swap_b32 v192, v196
    v_add_f32 v192, v192, v196
    v_mov_b32 v196, v192
    s_nop 1
    v_permlane32_swap_b32 v192, v196
    v_add_f32 v192, v192, v196
    v_mul_f32 v198, 0x3b124925, v192
    v_mov_b32 v199, v198
    v_pk_add_f32 v[196:197], v[40:41], v[198:199] neg_lo:[0,1] neg_hi:[0,1]
    v_pk_mul_f32 v[194:195], v[196:197], v[196:197]
    v_pk_add_f32 v[204:205], v[42:43], v[198:199] neg_lo:[0,1] neg_hi:[0,1]
    v_pk_fma_f32 v[194:195], v[204:205], v[204:205], v[194:195]
    v_pk_add_f32 v[196:197], v[44:45], v[198:199] neg_lo:[0,1] neg_hi:[0,1]
    v_pk_fma_f32 v[194:195], v[196:197], v[196:197], v[194:195]
    v_pk_add_f32 v[204:205], v[46:47], v[198:199] neg_lo:[0,1] neg_hi:[0,1]
    v_pk_fma_f32 v[194:195], v[204:205], v[204:205], v[194:195]
    v_pk_add_f32 v[196:197], v[48:49], v[198:199] neg_lo:[0,1] neg_hi:[0,1]
    v_pk_fma_f32 v[194:195], v[196:197], v[196:197], v[194:195]
    v_pk_add_f32 v[204:205], v[50:51], v[198:199] neg_lo:[0,1] neg_hi:[0,1]
    v_pk_fma_f32 v[194:195], v[204:205], v[204:205], v[194:195]
    v_pk_add_f32 v[196:197], v[52:53], v[198:199] neg_lo:[0,1] neg_hi:[0,1]
    v_pk_fma_f32 v[194:195], v[196:197], v[196:197], v[194:195]
    v_pk_add_f32 v[204:205], v[54:55], v[198:199] neg_lo:[0,1] neg_hi:[0,1]
    v_pk_fma_f32 v[194:195], v[204:205], v[204:205], v[194:195]
    v_pk_add_f32 v[196:197], v[56:57], v[198:199] neg_lo:[0,1] neg_hi:[0,1]
    v_pk_fma_f32 v[194:195], v[196:197], v[196:197], v[194:195]
    v_pk_add_f32 v[204:205], v[58:59], v[198:199] neg_lo:[0,1] neg_hi:[0,1]
    v_pk_fma_f32 v[194:195], v[204:205], v[204:205], v[194:195]
    v_pk_add_f32 v[196:197], v[60:61], v[198:199] neg_lo:[0,1] neg_hi:[0,1]
    v_pk_fma_f32 v[194:195], v[196:197], v[196:197], v[194:195]
    v_pk_add_f32 v[204:205], v[62:63], v[198:199] neg_lo:[0,1] neg_hi:[0,1]
    v_pk_fma_f32 v[194:195], v[204:205], v[204:205], v[194:195]
    v_pk_add_f32 v[196:197], v[64:65], v[198:199] neg_lo:[0,1] neg_hi:[0,1]
    v_pk_fma_f32 v[194:195], v[196:197], v[196:197], v[194:195]
    v_pk_add_f32 v[204:205], v[66:67], v[198:199] neg_lo:[0,1] neg_hi:[0,1]
    v_pk_fma_f32 v[194:195], v[204:205], v[204:205], v[194:195]
    v_pk_add_f32 v[196:197], v[68:69], v[198:199] neg_lo:[0,1] neg_hi:[0,1]
    v_pk_fma_f32 v[194:195], v[196:197], v[196:197], v[194:195]
    v_pk_add_f32 v[204:205], v[70:71], v[198:199] neg_lo:[0,1] neg_hi:[0,1]
    v_pk_fma_f32 v[194:195], v[204:205], v[204:205], v[194:195]
    v_pk_add_f32 v[196:197], v[72:73], v[198:199] neg_lo:[0,1] neg_hi:[0,1]
    v_pk_fma_f32 v[194:195], v[196:197], v[196:197], v[194:195]
    v_pk_add_f32 v[204:205], v[74:75], v[198:199] neg_lo:[0,1] neg_hi:[0,1]
    v_pk_fma_f32 v[194:195], v[204:205], v[204:205], v[194:195]
    v_pk_add_f32 v[196:197], v[76:77], v[198:199] neg_lo:[0,1] neg_hi:[0,1]
    v_pk_fma_f32 v[194:195], v[196:197], v[196:197], v[194:195]
    v_pk_add_f32 v[204:205], v[78:79], v[198:199] neg_lo:[0,1] neg_hi:[0,1]
    v_pk_fma_f32 v[194:195], v[204:205], v[204:205], v[194:195]
    v_pk_add_f32 v[196:197], v[80:81], v[198:199] neg_lo:[0,1] neg_hi:[0,1]
    v_pk_fma_f32 v[194:195], v[196:197], v[196:197], v[194:195]
    v_pk_add_f32 v[204:205], v[82:83], v[198:199] neg_lo:[0,1] neg_hi:[0,1]
    v_pk_fma_f32 v[194:195], v[204:205], v[204:205], v[194:195]
    v_pk_add_f32 v[196:197], v[84:85], v[198:199] neg_lo:[0,1] neg_hi:[0,1]
    v_pk_fma_f32 v[194:195], v[196:197], v[196:197], v[194:195]
    v_pk_add_f32 v[204:205], v[86:87], v[198:199] neg_lo:[0,1] neg_hi:[0,1]
    v_pk_fma_f32 v[194:195], v[204:205], v[204:205], v[194:195]
    v_pk_add_f32 v[196:197], v[88:89], v[198:199] neg_lo:[0,1] neg_hi:[0,1]
    v_pk_fma_f32 v[194:195], v[196:197], v[196:197], v[194:195]
    v_pk_add_f32 v[204:205], v[90:91], v[198:199] neg_lo:[0,1] neg_hi:[0,1]
    v_pk_fma_f32 v[194:195], v[204:205], v[204:205], v[194:195]
    v_pk_add_f32 v[196:197], v[92:93], v[198:199] neg_lo:[0,1] neg_hi:[0,1]
    v_pk_fma_f32 v[194:195], v[196:197], v[196:197], v[194:195]
    v_pk_add_f32 v[204:205], v[94:95], v[198:199] neg_lo:[0,1] neg_hi:[0,1]
    v_pk_fma_f32 v[194:195], v[204:205], v[204:205], v[194:195]
    v_pk_add_f32 v[196:197], v[96:97], v[198:199] neg_lo:[0,1] neg_hi:[0,1]
    v_pk_fma_f32 v[194:195], v[196:197], v[196:197], v[194:195]
    v_pk_add_f32 v[204:205], v[98:99], v[198:199] neg_lo:[0,1] neg_hi:[0,1]
    v_pk_fma_f32 v[194:195], v[204:205], v[204:205], v[194:195]
    v_pk_add_f32 v[196:197], v[100:101], v[198:199] neg_lo:[0,1] neg_hi:[0,1]
    v_pk_fma_f32 v[194:195], v[196:197], v[196:197], v[194:195]
    v_pk_add_f32 v[204:205], v[102:103], v[198:199] neg_lo:[0,1] neg_hi:[0,1]
    v_pk_fma_f32 v[194:195], v[204:205], v[204:205], v[194:195]
    v_pk_add_f32 v[196:197], v[104:105], v[198:199] neg_lo:[0,1] neg_hi:[0,1]
    v_pk_fma_f32 v[194:195], v[196:197], v[196:197], v[194:195]
    v_pk_add_f32 v[204:205], v[106:107], v[198:199] neg_lo:[0,1] neg_hi:[0,1]
    v_pk_fma_f32 v[194:195], v[204:205], v[204:205], v[194:195]
    v_pk_add_f32 v[196:197], v[108:109], v[198:199] neg_lo:[0,1] neg_hi:[0,1]
    v_pk_fma_f32 v[194:195], v[196:197], v[196:197], v[194:195]
    v_pk_add_f32 v[204:205], v[110:111], v[198:199] neg_lo:[0,1] neg_hi:[0,1]
    v_pk_fma_f32 v[194:195], v[204:205], v[204:205], v[194:195]
    v_pk_add_f32 v[196:197], v[112:113], v[198:199] neg_lo:[0,1] neg_hi:[0,1]
    v_pk_fma_f32 v[194:195], v[196:197], v[196:197], v[194:195]
    v_pk_add_f32 v[204:205], v[114:115], v[198:199] neg_lo:[0,1] neg_hi:[0,1]
    v_pk_fma_f32 v[194:195], v[204:205], v[204:205], v[194:195]
    v_pk_add_f32 v[196:197], v[116:117], v[198:199] neg_lo:[0,1] neg_hi:[0,1]
    v_pk_fma_f32 v[194:195], v[196:197], v[196:197], v[194:195]
    v_pk_add_f32 v[204:205], v[118:119], v[198:199] neg_lo:[0,1] neg_hi:[0,1]
    v_pk_fma_f32 v[194:195], v[204:205], v[204:205], v[194:195]
    v_pk_add_f32 v[196:197], v[120:121], v[198:199] neg_lo:[0,1] neg_hi:[0,1]
    v_pk_fma_f32 v[194:195], v[196:197], v[196:197], v[194:195]
    v_pk_add_f32 v[204:205], v[122:123], v[198:199] neg_lo:[0,1] neg_hi:[0,1]
    v_pk_fma_f32 v[194:195], v[204:205], v[204:205], v[194:195]
    v_pk_add_f32 v[196:197], v[124:125], v[198:199] neg_lo:[0,1] neg_hi:[0,1]
    v_pk_fma_f32 v[194:195], v[196:197], v[196:197], v[194:195]
    v_pk_add_f32 v[204:205], v[126:127], v[198:199] neg_lo:[0,1] neg_hi:[0,1]
    v_pk_fma_f32 v[194:195], v[204:205], v[204:205], v[194:195]
    v_pk_add_f32 v[196:197], v[128:129], v[198:199] neg_lo:[0,1] neg_hi:[0,1]
    v_pk_fma_f32 v[194:195], v[196:197], v[196:197], v[194:195]
    v_pk_add_f32 v[204:205], v[130:131], v[198:199] neg_lo:[0,1] neg_hi:[0,1]
    v_pk_fma_f32 v[194:195], v[204:205], v[204:205], v[194:195]
    v_pk_add_f32 v[196:197], v[132:133], v[198:199] neg_lo:[0,1] neg_hi:[0,1]
    v_pk_fma_f32 v[194:195], v[196:197], v[196:197], v[194:195]
    v_pk_add_f32 v[204:205], v[134:135], v[198:199] neg_lo:[0,1] neg_hi:[0,1]
    v_pk_fma_f32 v[194:195], v[204:205], v[204:205], v[194:195]
    v_pk_add_f32 v[196:197], v[136:137], v[198:199] neg_lo:[0,1] neg_hi:[0,1]
    v_pk_fma_f32 v[194:195], v[196:197], v[196:197], v[194:195]
    v_pk_add_f32 v[204:205], v[138:139], v[198:199] neg_lo:[0,1] neg_hi:[0,1]
    v_pk_fma_f32 v[194:195], v[204:205], v[204:205], v[194:195]
    v_pk_add_f32 v[196:197], v[140:141], v[198:199] neg_lo:[0,1] neg_hi:[0,1]
    v_pk_fma_f32 v[194:195], v[196:197], v[196:197], v[194:195]
    v_pk_add_f32 v[204:205], v[142:143], v[198:199] neg_lo:[0,1] neg_hi:[0,1]
    v_pk_fma_f32 v[194:195], v[204:205], v[204:205], v[194:195]
    v_pk_add_f32 v[196:197], v[144:145], v[198:199] neg_lo:[0,1] neg_hi:[0,1]
    v_pk_fma_f32 v[194:195], v[196:197], v[196:197], v[194:195]
    v_pk_add_f32 v[204:205], v[146:147], v[198:199] neg_lo:[0,1] neg_hi:[0,1]
    v_pk_fma_f32 v[194:195], v[204:205], v[204:205], v[194:195]
    v_pk_add_f32 v[196:197], v[148:149], v[198:199] neg_lo:[0,1] neg_hi:[0,1]
    v_pk_fma_f32 v[194:195], v[196:197], v[196:197], v[194:195]
    v_pk_add_f32 v[204:205], v[150:151], v[198:199] neg_lo:[0,1] neg_hi:[0,1]
    v_pk_fma_f32 v[194:195], v[204:205], v[204:205], v[194:195]
    v_add_f32 v194, v194, v195
    v_mov_b32 v196, v194
    s_nop 1
    v_permlane16_swap_b32 v194, v196
    v_add_f32 v194, v194, v196
    v_mov_b32 v196, v194
    s_nop 1
    v_permlane32_swap_b32 v194, v196
    v_add_f32 v194, v194, v196
    v_mul_f32 v194, 0x3b124925, v194
    v_cvt_pk_bf16_f32 v196, v198, v194
    v_lshlrev_b32 v200, 16, v196
    v_mov_b32 v201, v200
    v_and_b32 v196, s15, v196
    v_add_f32 v196, 0x3727c5ac, v196
    v_cvt_pk_bf16_f32 v196, v196, v196
    v_and_b32 v196, s15, v196
    v_sqrt_f32 v196, v196
    s_nop 0
    v_cvt_pk_bf16_f32 v196, v196, v196
    v_and_b32 v196, s15, v196
    v_rcp_f32 v202, v196
    s_nop 0
    v_mov_b32 v203, v202
    v_pk_add_f32 v[196:197], v[40:41], v[200:201] neg_lo:[0,1] neg_hi:[0,1]
    v_cvt_pk_bf16_f32 v196, v196, v197
    v_and_b32 v197, s15, v196
    v_lshlrev_b32 v196, 16, v196
    v_pk_mul_f32 v[196:197], v[196:197], v[202:203]
    v_cvt_pk_bf16_f32 v16, v196, v197
    v_pk_add_f32 v[204:205], v[42:43], v[200:201] neg_lo:[0,1] neg_hi:[0,1]
    v_cvt_pk_bf16_f32 v204, v204, v205
    v_and_b32 v205, s15, v204
    v_lshlrev_b32 v204, 16, v204
    v_pk_mul_f32 v[204:205], v[204:205], v[202:203]
    v_cvt_pk_bf16_f32 v17, v204, v205
    v_pk_add_f32 v[196:197], v[44:45], v[200:201] neg_lo:[0,1] neg_hi:[0,1]
    v_cvt_pk_bf16_f32 v196, v196, v197
    v_and_b32 v197, s15, v196
    v_lshlrev_b32 v196, 16, v196
    v_pk_mul_f32 v[196:197], v[196:197], v[202:203]
    v_cvt_pk_bf16_f32 v18, v196, v197
    v_pk_add_f32 v[204:205], v[46:47], v[200:201] neg_lo:[0,1] neg_hi:[0,1]
    v_cvt_pk_bf16_f32 v204, v204, v205
    v_and_b32 v205, s15, v204
    v_lshlrev_b32 v204, 16, v204
    v_pk_mul_f32 v[204:205], v[204:205], v[202:203]
    v_cvt_pk_bf16_f32 v19, v204, v205
    ds_write_b128 v211, v[16:19] offset:0
    v_pk_add_f32 v[196:197], v[48:49], v[200:201] neg_lo:[0,1] neg_hi:[0,1]
    v_cvt_pk_bf16_f32 v196, v196, v197
    v_and_b32 v197, s15, v196
    v_lshlrev_b32 v196, 16, v196
    v_pk_mul_f32 v[196:197], v[196:197], v[202:203]
    v_cvt_pk_bf16_f32 v20, v196, v197
    v_pk_add_f32 v[204:205], v[50:51], v[200:201] neg_lo:[0,1] neg_hi:[0,1]
    v_cvt_pk_bf16_f32 v204, v204, v205
    v_and_b32 v205, s15, v204
    v_lshlrev_b32 v204, 16, v204
    v_pk_mul_f32 v[204:205], v[204:205], v[202:203]
    v_cvt_pk_bf16_f32 v21, v204, v205
    v_pk_add_f32 v[196:197], v[52:53], v[200:201] neg_lo:[0,1] neg_hi:[0,1]
    v_cvt_pk_bf16_f32 v196, v196, v197
    v_and_b32 v197, s15, v196
    v_lshlrev_b32 v196, 16, v196
    v_pk_mul_f32 v[196:197], v[196:197], v[202:203]
    v_cvt_pk_bf16_f32 v22, v196, v197
    v_pk_add_f32 v[204:205], v[54:55], v[200:201] neg_lo:[0,1] neg_hi:[0,1]
    v_cvt_pk_bf16_f32 v204, v204, v205
    v_and_b32 v205, s15, v204
    v_lshlrev_b32 v204, 16, v204
    v_pk_mul_f32 v[204:205], v[204:205], v[202:203]
    v_cvt_pk_bf16_f32 v23, v204, v205
    ds_write_b128 v211, v[20:23] offset:1024
    v_pk_add_f32 v[196:197], v[56:57], v[200:201] neg_lo:[0,1] neg_hi:[0,1]
    v_cvt_pk_bf16_f32 v196, v196, v197
    v_and_b32 v197, s15, v196
    v_lshlrev_b32 v196, 16, v196
    v_pk_mul_f32 v[196:197], v[196:197], v[202:203]
    v_cvt_pk_bf16_f32 v16, v196, v197
    v_pk_add_f32 v[204:205], v[58:59], v[200:201] neg_lo:[0,1] neg_hi:[0,1]
    v_cvt_pk_bf16_f32 v204, v204, v205
    v_and_b32 v205, s15, v204
    v_lshlrev_b32 v204, 16, v204
    v_pk_mul_f32 v[204:205], v[204:205], v[202:203]
    v_cvt_pk_bf16_f32 v17, v204, v205
    v_pk_add_f32 v[196:197], v[60:61], v[200:201] neg_lo:[0,1] neg_hi:[0,1]
    v_cvt_pk_bf16_f32 v196, v196, v197
    v_and_b32 v197, s15, v196
    v_lshlrev_b32 v196, 16, v196
    v_pk_mul_f32 v[196:197], v[196:197], v[202:203]
    v_cvt_pk_bf16_f32 v18, v196, v197
    v_pk_add_f32 v[204:205], v[62:63], v[200:201] neg_lo:[0,1] neg_hi:[0,1]
    v_cvt_pk_bf16_f32 v204, v204, v205
    v_and_b32 v205, s15, v204
    v_lshlrev_b32 v204, 16, v204
    v_pk_mul_f32 v[204:205], v[204:205], v[202:203]
    v_cvt_pk_bf16_f32 v19, v204, v205
    ds_write_b128 v211, v[16:19] offset:2048
    v_pk_add_f32 v[196:197], v[64:65], v[200:201] neg_lo:[0,1] neg_hi:[0,1]
    v_cvt_pk_bf16_f32 v196, v196, v197
    v_and_b32 v197, s15, v196
    v_lshlrev_b32 v196, 16, v196
    v_pk_mul_f32 v[196:197], v[196:197], v[202:203]
    v_cvt_pk_bf16_f32 v20, v196, v197
    v_pk_add_f32 v[204:205], v[66:67], v[200:201] neg_lo:[0,1] neg_hi:[0,1]
    v_cvt_pk_bf16_f32 v204, v204, v205
    v_and_b32 v205, s15, v204
    v_lshlrev_b32 v204, 16, v204
    v_pk_mul_f32 v[204:205], v[204:205], v[202:203]
    v_cvt_pk_bf16_f32 v21, v204, v205
    v_pk_add_f32 v[196:197], v[68:69], v[200:201] neg_lo:[0,1] neg_hi:[0,1]
    v_cvt_pk_bf16_f32 v196, v196, v197
    v_and_b32 v197, s15, v196
    v_lshlrev_b32 v196, 16, v196
    v_pk_mul_f32 v[196:197], v[196:197], v[202:203]
    v_cvt_pk_bf16_f32 v22, v196, v197
    v_pk_add_f32 v[204:205], v[70:71], v[200:201] neg_lo:[0,1] neg_hi:[0,1]
    v_cvt_pk_bf16_f32 v204, v204, v205
    v_and_b32 v205, s15, v204
    v_lshlrev_b32 v204, 16, v204
    v_pk_mul_f32 v[204:205], v[204:205], v[202:203]
    v_cvt_pk_bf16_f32 v23, v204, v205
    ds_write_b128 v211, v[20:23] offset:3072
    v_pk_add_f32 v[196:197], v[72:73], v[200:201] neg_lo:[0,1] neg_hi:[0,1]
    v_cvt_pk_bf16_f32 v196, v196, v197
    v_and_b32 v197, s15, v196
    v_lshlrev_b32 v196, 16, v196
    v_pk_mul_f32 v[196:197], v[196:197], v[202:203]
    v_cvt_pk_bf16_f32 v16, v196, v197
    v_pk_add_f32 v[204:205], v[74:75], v[200:201] neg_lo:[0,1] neg_hi:[0,1]
    v_cvt_pk_bf16_f32 v204, v204, v205
    v_and_b32 v205, s15, v204
    v_lshlrev_b32 v204, 16, v204
    v_pk_mul_f32 v[204:205], v[204:205], v[202:203]
    v_cvt_pk_bf16_f32 v17, v204, v205
    v_pk_add_f32 v[196:197], v[76:77], v[200:201] neg_lo:[0,1] neg_hi:[0,1]
    v_cvt_pk_bf16_f32 v196, v196, v197
    v_and_b32 v197, s15, v196
    v_lshlrev_b32 v196, 16, v196
    v_pk_mul_f32 v[196:197], v[196:197], v[202:203]
    v_cvt_pk_bf16_f32 v18, v196, v197
    v_pk_add_f32 v[204:205], v[78:79], v[200:201] neg_lo:[0,1] neg_hi:[0,1]
    v_cvt_pk_bf16_f32 v204, v204, v205
    v_and_b32 v205, s15, v204
    v_lshlrev_b32 v204, 16, v204
    v_pk_mul_f32 v[204:205], v[204:205], v[202:203]
    v_cvt_pk_bf16_f32 v19, v204, v205
    ds_write_b128 v211, v[16:19] offset:4096
    v_pk_add_f32 v[196:197], v[80:81], v[200:201] neg_lo:[0,1] neg_hi:[0,1]
    v_cvt_pk_bf16_f32 v196, v196, v197
    v_and_b32 v197, s15, v196
    v_lshlrev_b32 v196, 16, v196
    v_pk_mul_f32 v[196:197], v[196:197], v[202:203]
    v_cvt_pk_bf16_f32 v20, v196, v197
    v_pk_add_f32 v[204:205], v[82:83], v[200:201] neg_lo:[0,1] neg_hi:[0,1]
    v_cvt_pk_bf16_f32 v204, v204, v205
    v_and_b32 v205, s15, v204
    v_lshlrev_b32 v204, 16, v204
    v_pk_mul_f32 v[204:205], v[204:205], v[202:203]
    v_cvt_pk_bf16_f32 v21, v204, v205
    v_pk_add_f32 v[196:197], v[84:85], v[200:201] neg_lo:[0,1] neg_hi:[0,1]
    v_cvt_pk_bf16_f32 v196, v196, v197
    v_and_b32 v197, s15, v196
    v_lshlrev_b32 v196, 16, v196
    v_pk_mul_f32 v[196:197], v[196:197], v[202:203]
    v_cvt_pk_bf16_f32 v22, v196, v197
    v_pk_add_f32 v[204:205], v[86:87], v[200:201] neg_lo:[0,1] neg_hi:[0,1]
    v_cvt_pk_bf16_f32 v204, v204, v205
    v_and_b32 v205, s15, v204
    v_lshlrev_b32 v204, 16, v204
    v_pk_mul_f32 v[204:205], v[204:205], v[202:203]
    v_cvt_pk_bf16_f32 v23, v204, v205
    ds_write_b128 v211, v[20:23] offset:5120
    v_pk_add_f32 v[196:197], v[88:89], v[200:201] neg_lo:[0,1] neg_hi:[0,1]
    v_cvt_pk_bf16_f32 v196, v196, v197
    v_and_b32 v197, s15, v196
    v_lshlrev_b32 v196, 16, v196
    v_pk_mul_f32 v[196:197], v[196:197], v[202:203]
    v_cvt_pk_bf16_f32 v16, v196, v197
    v_pk_add_f32 v[204:205], v[90:91], v[200:201] neg_lo:[0,1] neg_hi:[0,1]
    v_cvt_pk_bf16_f32 v204, v204, v205
    v_and_b32 v205, s15, v204
    v_lshlrev_b32 v204, 16, v204
    v_pk_mul_f32 v[204:205], v[204:205], v[202:203]
    v_cvt_pk_bf16_f32 v17, v204, v205
    v_pk_add_f32 v[196:197], v[92:93], v[200:201] neg_lo:[0,1] neg_hi:[0,1]
    v_cvt_pk_bf16_f32 v196, v196, v197
    v_and_b32 v197, s15, v196
    v_lshlrev_b32 v196, 16, v196
    v_pk_mul_f32 v[196:197], v[196:197], v[202:203]
    v_cvt_pk_bf16_f32 v18, v196, v197
    v_pk_add_f32 v[204:205], v[94:95], v[200:201] neg_lo:[0,1] neg_hi:[0,1]
    v_cvt_pk_bf16_f32 v204, v204, v205
    v_and_b32 v205, s15, v204
    v_lshlrev_b32 v204, 16, v204
    v_pk_mul_f32 v[204:205], v[204:205], v[202:203]
    v_cvt_pk_bf16_f32 v19, v204, v205
    ds_write_b128 v211, v[16:19] offset:6144
    v_pk_add_f32 v[196:197], v[96:97], v[200:201] neg_lo:[0,1] neg_hi:[0,1]
    v_cvt_pk_bf16_f32 v196, v196, v197
    v_and_b32 v197, s15, v196
    v_lshlrev_b32 v196, 16, v196
    v_pk_mul_f32 v[196:197], v[196:197], v[202:203]
    v_cvt_pk_bf16_f32 v20, v196, v197
    v_pk_add_f32 v[204:205], v[98:99], v[200:201] neg_lo:[0,1] neg_hi:[0,1]
    v_cvt_pk_bf16_f32 v204, v204, v205
    v_and_b32 v205, s15, v204
    v_lshlrev_b32 v204, 16, v204
    v_pk_mul_f32 v[204:205], v[204:205], v[202:203]
    v_cvt_pk_bf16_f32 v21, v204, v205
    v_pk_add_f32 v[196:197], v[100:101], v[200:201] neg_lo:[0,1] neg_hi:[0,1]
    v_cvt_pk_bf16_f32 v196, v196, v197
    v_and_b32 v197, s15, v196
    v_lshlrev_b32 v196, 16, v196
    v_pk_mul_f32 v[196:197], v[196:197], v[202:203]
    v_cvt_pk_bf16_f32 v22, v196, v197
    v_pk_add_f32 v[204:205], v[102:103], v[200:201] neg_lo:[0,1] neg_hi:[0,1]
    v_cvt_pk_bf16_f32 v204, v204, v205
    v_and_b32 v205, s15, v204
    v_lshlrev_b32 v204, 16, v204
    v_pk_mul_f32 v[204:205], v[204:205], v[202:203]
    v_cvt_pk_bf16_f32 v23, v204, v205
    ds_write_b128 v211, v[20:23] offset:7168
    v_pk_add_f32 v[196:197], v[104:105], v[200:201] neg_lo:[0,1] neg_hi:[0,1]
    v_cvt_pk_bf16_f32 v196, v196, v197
    v_and_b32 v197, s15, v196
    v_lshlrev_b32 v196, 16, v196
    v_pk_mul_f32 v[196:197], v[196:197], v[202:203]
    v_cvt_pk_bf16_f32 v16, v196, v197
    v_pk_add_f32 v[204:205], v[106:107], v[200:201] neg_lo:[0,1] neg_hi:[0,1]
    v_cvt_pk_bf16_f32 v204, v204, v205
    v_and_b32 v205, s15, v204
    v_lshlrev_b32 v204, 16, v204
    v_pk_mul_f32 v[204:205], v[204:205], v[202:203]
    v_cvt_pk_bf16_f32 v17, v204, v205
    v_pk_add_f32 v[196:197], v[108:109], v[200:201] neg_lo:[0,1] neg_hi:[0,1]
    v_cvt_pk_bf16_f32 v196, v196, v197
    v_and_b32 v197, s15, v196
    v_lshlrev_b32 v196, 16, v196
    v_pk_mul_f32 v[196:197], v[196:197], v[202:203]
    v_cvt_pk_bf16_f32 v18, v196, v197
    v_pk_add_f32 v[204:205], v[110:111], v[200:201] neg_lo:[0,1] neg_hi:[0,1]
    v_cvt_pk_bf16_f32 v204, v204, v205
    v_and_b32 v205, s15, v204
    v_lshlrev_b32 v204, 16, v204
    v_pk_mul_f32 v[204:205], v[204:205], v[202:203]
    v_cvt_pk_bf16_f32 v19, v204, v205
    ds_write_b128 v211, v[16:19] offset:8192
    v_pk_add_f32 v[196:197], v[112:113], v[200:201] neg_lo:[0,1] neg_hi:[0,1]
    v_cvt_pk_bf16_f32 v196, v196, v197
    v_and_b32 v197, s15, v196
    v_lshlrev_b32 v196, 16, v196
    v_pk_mul_f32 v[196:197], v[196:197], v[202:203]
    v_cvt_pk_bf16_f32 v20, v196, v197
    v_pk_add_f32 v[204:205], v[114:115], v[200:201] neg_lo:[0,1] neg_hi:[0,1]
    v_cvt_pk_bf16_f32 v204, v204, v205
    v_and_b32 v205, s15, v204
    v_lshlrev_b32 v204, 16, v204
    v_pk_mul_f32 v[204:205], v[204:205], v[202:203]
    v_cvt_pk_bf16_f32 v21, v204, v205
    v_pk_add_f32 v[196:197], v[116:117], v[200:201] neg_lo:[0,1] neg_hi:[0,1]
    v_cvt_pk_bf16_f32 v196, v196, v197
    v_and_b32 v197, s15, v196
    v_lshlrev_b32 v196, 16, v196
    v_pk_mul_f32 v[196:197], v[196:197], v[202:203]
    v_cvt_pk_bf16_f32 v22, v196, v197
    v_pk_add_f32 v[204:205], v[118:119], v[200:201] neg_lo:[0,1] neg_hi:[0,1]
    v_cvt_pk_bf16_f32 v204, v204, v205
    v_and_b32 v205, s15, v204
    v_lshlrev_b32 v204, 16, v204
    v_pk_mul_f32 v[204:205], v[204:205], v[202:203]
    v_cvt_pk_bf16_f32 v23, v204, v205
    ds_write_b128 v211, v[20:23] offset:9216
    v_pk_add_f32 v[196:197], v[120:121], v[200:201] neg_lo:[0,1] neg_hi:[0,1]
    v_cvt_pk_bf16_f32 v196, v196, v197
    v_and_b32 v197, s15, v196
    v_lshlrev_b32 v196, 16, v196
    v_pk_mul_f32 v[196:197], v[196:197], v[202:203]
    v_cvt_pk_bf16_f32 v16, v196, v197
    v_pk_add_f32 v[204:205], v[122:123], v[200:201] neg_lo:[0,1] neg_hi:[0,1]
    v_cvt_pk_bf16_f32 v204, v204, v205
    v_and_b32 v205, s15, v204
    v_lshlrev_b32 v204, 16, v204
    v_pk_mul_f32 v[204:205], v[204:205], v[202:203]
    v_cvt_pk_bf16_f32 v17, v204, v205
    v_pk_add_f32 v[196:197], v[124:125], v[200:201] neg_lo:[0,1] neg_hi:[0,1]
    v_cvt_pk_bf16_f32 v196, v196, v197
    v_and_b32 v197, s15, v196
    v_lshlrev_b32 v196, 16, v196
    v_pk_mul_f32 v[196:197], v[196:197], v[202:203]
    v_cvt_pk_bf16_f32 v18, v196, v197
    v_pk_add_f32 v[204:205], v[126:127], v[200:201] neg_lo:[0,1] neg_hi:[0,1]
    v_cvt_pk_bf16_f32 v204, v204, v205
    v_and_b32 v205, s15, v204
    v_lshlrev_b32 v204, 16, v204
    v_pk_mul_f32 v[204:205], v[204:205], v[202:203]
    v_cvt_pk_bf16_f32 v19, v204, v205
    ds_write_b128 v211, v[16:19] offset:10240
    global_load_dwordx4 v[40:43], v208, s[32:33] offset:0
    global_load_dwordx4 v[44:47], v209, s[32:33] offset:0
    v_pk_add_f32 v[196:197], v[128:129], v[200:201] neg_lo:[0,1] neg_hi:[0,1]
    v_cvt_pk_bf16_f32 v196, v196, v197
    v_and_b32 v197, s15, v196
    v_lshlrev_b32 v196, 16, v196
    v_pk_mul_f32 v[196:197], v[196:197], v[202:203]
    v_cvt_pk_bf16_f32 v20, v196, v197
    v_pk_add_f32 v[204:205], v[130:131], v[200:201] neg_lo:[0,1] neg_hi:[0,1]
    v_cvt_pk_bf16_f32 v204, v204, v205
    v_and_b32 v205, s15, v204
    v_lshlrev_b32 v204, 16, v204
    v_pk_mul_f32 v[204:205], v[204:205], v[202:203]
    v_cvt_pk_bf16_f32 v21, v204, v205
    v_pk_add_f32 v[196:197], v[132:133], v[200:201] neg_lo:[0,1] neg_hi:[0,1]
    v_cvt_pk_bf16_f32 v196, v196, v197
    v_and_b32 v197, s15, v196
    v_lshlrev_b32 v196, 16, v196
    v_pk_mul_f32 v[196:197], v[196:197], v[202:203]
    v_cvt_pk_bf16_f32 v22, v196, v197
    v_pk_add_f32 v[204:205], v[134:135], v[200:201] neg_lo:[0,1] neg_hi:[0,1]
    v_cvt_pk_bf16_f32 v204, v204, v205
    v_and_b32 v205, s15, v204
    v_lshlrev_b32 v204, 16, v204
    v_pk_mul_f32 v[204:205], v[204:205], v[202:203]
    v_cvt_pk_bf16_f32 v23, v204, v205
    ds_write_b128 v211, v[20:23] offset:11264
    global_load_dwordx4 v[48:51], v208, s[32:33] offset:1024
    global_load_dwordx4 v[52:55], v209, s[32:33] offset:1024
    v_pk_add_f32 v[196:197], v[136:137], v[200:201] neg_lo:[0,1] neg_hi:[0,1]
    v_cvt_pk_bf16_f32 v196, v196, v197
    v_and_b32 v197, s15, v196
    v_lshlrev_b32 v196, 16, v196
    v_pk_mul_f32 v[196:197], v[196:197], v[202:203]
    v_cvt_pk_bf16_f32 v16, v196, v197
    v_pk_add_f32 v[204:205], v[138:139], v[200:201] neg_lo:[0,1] neg_hi:[0,1]
    v_cvt_pk_bf16_f32 v204, v204, v205
    v_and_b32 v205, s15, v204
    v_lshlrev_b32 v204, 16, v204
    v_pk_mul_f32 v[204:205], v[204:205], v[202:203]
    v_cvt_pk_bf16_f32 v17, v204, v205
    v_pk_add_f32 v[196:197], v[140:141], v[200:201] neg_lo:[0,1] neg_hi:[0,1]
    v_cvt_pk_bf16_f32 v196, v196, v197
    v_and_b32 v197, s15, v196
    v_lshlrev_b32 v196, 16, v196
    v_pk_mul_f32 v[196:197], v[196:197], v[202:203]
    v_cvt_pk_bf16_f32 v18, v196, v197
    v_pk_add_f32 v[204:205], v[142:143], v[200:201] neg_lo:[0,1] neg_hi:[0,1]
    v_cvt_pk_bf16_f32 v204, v204, v205
    v_and_b32 v205, s15, v204
    v_lshlrev_b32 v204, 16, v204
    v_pk_mul_f32 v[204:205], v[204:205], v[202:203]
    v_cvt_pk_bf16_f32 v19, v204, v205
    ds_write_b128 v211, v[16:19] offset:12288
    global_load_dwordx4 v[56:59], v208, s[32:33] offset:2048
    global_load_dwordx4 v[60:63], v209, s[32:33] offset:2048
    v_pk_add_f32 v[196:197], v[144:145], v[200:201] neg_lo:[0,1] neg_hi:[0,1]
    v_cvt_pk_bf16_f32 v196, v196, v197
    v_and_b32 v197, s15, v196
    v_lshlrev_b32 v196, 16, v196
    v_pk_mul_f32 v[196:197], v[196:197], v[202:203]
    v_cvt_pk_bf16_f32 v20, v196, v197
    v_pk_add_f32 v[204:205], v[146:147], v[200:201] neg_lo:[0,1] neg_hi:[0,1]
    v_cvt_pk_bf16_f32 v204, v204, v205
    v_and_b32 v205, s15, v204
    v_lshlrev_b32 v204, 16, v204
    v_pk_mul_f32 v[204:205], v[204:205], v[202:203]
    v_cvt_pk_bf16_f32 v21, v204, v205
    v_pk_add_f32 v[196:197], v[148:149], v[200:201] neg_lo:[0,1] neg_hi:[0,1]
    v_cvt_pk_bf16_f32 v196, v196, v197
    v_and_b32 v197, s15, v196
    v_lshlrev_b32 v196, 16, v196
    v_pk_mul_f32 v[196:197], v[196:197], v[202:203]
    v_cvt_pk_bf16_f32 v22, v196, v197
    v_pk_add_f32 v[204:205], v[150:151], v[200:201] neg_lo:[0,1] neg_hi:[0,1]
    v_cvt_pk_bf16_f32 v204, v204, v205
    v_and_b32 v205, s15, v204
    v_lshlrev_b32 v204, 16, v204
    v_pk_mul_f32 v[204:205], v[204:205], v[202:203]
    v_cvt_pk_bf16_f32 v23, v204, v205
    ds_write_b128 v211, v[20:23] offset:13312
    global_load_dwordx4 v[64:67], v208, s[32:33] offset:3072
    global_load_dwordx4 v[68:71], v209, s[32:33] offset:3072
    s_waitcnt lgkmcnt(0)
    s_barrier
    v_add_u32 v208, 4096, v208
    global_load_dwordx4 v[72:75], v208, s[32:33] offset:0
    v_add_u32 v209, 4096, v209
    global_load_dwordx4 v[76:79], v209, s[32:33] offset:0
    global_load_dwordx4 v[80:83], v208, s[32:33] offset:1024
    global_load_dwordx4 v[84:87], v209, s[32:33] offset:1024
    global_load_dwordx4 v[88:91], v208, s[32:33] offset:2048
    global_load_dwordx4 v[92:95], v209, s[32:33] offset:2048
    global_load_dwordx4 v[96:99], v208, s[32:33] offset:3072
    global_load_dwordx4 v[100:103], v209, s[32:33] offset:3072
    v_add_u32 v208, 4096, v208
    global_load_dwordx4 v[104:107], v208, s[32:33] offset:0
    v_add_u32 v209, 4096, v209
    global_load_dwordx4 v[108:111], v209, s[32:33] offset:0
    global_load_dwordx4 v[112:115], v208, s[32:33] offset:1024
    global_load_dwordx4 v[116:119], v209, s[32:33] offset:1024
    global_load_dwordx4 v[120:123], v208, s[32:33] offset:2048
    global_load_dwordx4 v[124:127], v209, s[32:33] offset:2048
    global_load_dwordx4 v[128:131], v208, s[32:33] offset:3072
    global_load_dwordx4 v[132:135], v209, s[32:33] offset:3072
    v_add_u32 v208, 4096, v208
    global_load_dwordx4 v[136:139], v208, s[32:33] offset:0
    v_add_u32 v209, 4096, v209
    global_load_dwordx4 v[140:143], v209, s[32:33] offset:0
    global_load_dwordx4 v[144:147], v208, s[32:33] offset:1024
    global_load_dwordx4 v[148:151], v209, s[32:33] offset:1024
    s_branch K3_MAIN2
K3_MAIN:
    s_barrier
K3_MAIN2:
    ds_read_b128 v[8:11], v214 offset:0
    ds_read_b128 v[12:15], v214 offset:14336
    ds_read_b128 v[16:19], v214 offset:28672
    ds_read_b128 v[20:23], v214 offset:43008
    s_waitcnt vmcnt(26) lgkmcnt(0)
    v_mfma_f32_16x16x32_bf16 v[152:155], v[40:43], v[8:11], 0
    ds_read_b128 v[24:27], v214 offset:1024
    v_mfma_f32_16x16x32_bf16 v[156:159], v[40:43], v[12:15], 0
    ds_read_b128 v[28:31], v214 offset:15360
    v_mfma_f32_16x16x32_bf16 v[160:163], v[40:43], v[16:19], 0
    ds_read_b128 v[32:35], v214 offset:29696
    v_mfma_f32_16x16x32_bf16 v[164:167], v[40:43], v[20:23], 0
    ds_read_b128 v[36:39], v214 offset:44032
    v_mfma_f32_16x16x32_bf16 v[168:171], v[44:47], v[8:11], 0
    v_mfma_f32_16x16x32_bf16 v[172:175], v[44:47], v[12:15], 0
    v_mfma_f32_16x16x32_bf16 v[176:179], v[44:47], v[16:19], 0
    v_mfma_f32_16x16x32_bf16 v[180:183], v[44:47], v[20:23], 0
    s_waitcnt vmcnt(24) lgkmcnt(0)
    v_mfma_f32_16x16x32_bf16 v[152:155], v[48:51], v[24:27], v[152:155]
    ds_read_b128 v[8:11], v214 offset:2048
    v_mfma_f32_16x16x32_bf16 v[156:159], v[48:51], v[28:31], v[156:159]
    ds_read_b128 v[12:15], v214 offset:16384
    v_mfma_f32_16x16x32_bf16 v[160:163], v[48:51], v[32:35], v[160:163]
    ds_read_b128 v[16:19], v214 offset:30720
    v_mfma_f32_16x16x32_bf16 v[164:167], v[48:51], v[36:39], v[164:167]
    ds_read_b128 v[20:23], v214 offset:45056
    v_mfma_f32_16x16x32_bf16 v[168:171], v[52:55], v[24:27], v[168:171]
    v_mfma_f32_16x16x32_bf16 v[172:175], v[52:55], v[28:31], v[172:175]
    v_mfma_f32_16x16x32_bf16 v[176:179], v[52:55], v[32:35], v[176:179]
    v_mfma_f32_16x16x32_bf16 v[180:183], v[52:55], v[36:39], v[180:183]
    s_waitcnt vmcnt(22) lgkmcnt(0)
    v_mfma_f32_16x16x32_bf16 v[152:155], v[56:59], v[8:11], v[152:155]
    ds_read_b128 v[24:27], v214 offset:3072
    v_mfma_f32_16x16x32_bf16 v[156:159], v[56:59], v[12:15], v[156:159]
    ds_read_b128 v[28:31], v214 offset:17408
    v_mfma_f32_16x16x32_bf16 v[160:163], v[56:59], v[16:19], v[160:163]
    ds_read_b128 v[32:35], v214 offset:31744
    v_mfma_f32_16x16x32_bf16 v[164:167], v[56:59], v[20:23], v[164:167]
    ds_read_b128 v[36:39], v214 offset:46080
    v_mfma_f32_16x16x32_bf16 v[168:171], v[60:63], v[8:11], v[168:171]
    v_mfma_f32_16x16x32_bf16 v[172:175], v[60:63], v[12:15], v[172:175]
    v_mfma_f32_16x16x32_bf16 v[176:179], v[60:63], v[16:19], v[176:179]
    v_mfma_f32_16x16x32_bf16 v[180:183], v[60:63], v[20:23], v[180:183]
    s_waitcnt vmcnt(20) lgkmcnt(0)
    v_mfma_f32_16x16x32_bf16 v[152:155], v[64:67], v[24:27], v[152:155]
    ds_read_b128 v[8:11], v214 offset:4096
    v_mfma_f32_16x16x32_bf16 v[156:159], v[64:67], v[28:31], v[156:159]
    ds_read_b128 v[12:15], v214 offset:18432
    v_mfma_f32_16x16x32_bf16 v[160:163], v[64:67], v[32:35], v[160:163]
    ds_read_b128 v[16:19], v214 offset:32768
    v_mfma_f32_16x16x32_bf16 v[164:167], v[64:67], v[36:39], v[164:167]
    ds_read_b128 v[20:23], v214 offset:47104
    v_mfma_f32_16x16x32_bf16 v[168:171], v[68:71], v[24:27], v[168:171]
    v_mfma_f32_16x16x32_bf16 v[172:175], v[68:71], v[28:31], v[172:175]
    v_mfma_f32_16x16x32_bf16 v[176:179], v[68:71], v[32:35], v[176:179]
    v_mfma_f32_16x16x32_bf16 v[180:183], v[68:71], v[36:39], v[180:183]
    s_waitcnt vmcnt(18) lgkmcnt(0)
    v_mfma_f32_16x16x32_bf16 v[152:155], v[72:75], v[8:11], v[152:155]
    ds_read_b128 v[24:27], v214 offset:5120
    v_mfma_f32_16x16x32_bf16 v[156:159], v[72:75], v[12:15], v[156:159]
    ds_read_b128 v[28:31], v214 offset:19456
    v_mfma_f32_16x16x32_bf16 v[160:163], v[72:75], v[16:19], v[160:163]
    ds_read_b128 v[32:35], v214 offset:33792
    v_mfma_f32_16x16x32_bf16 v[164:167], v[72:75], v[20:23], v[164:167]
    ds_read_b128 v[36:39], v214 offset:48128
    v_mfma_f32_16x16x32_bf16 v[168:171], v[76:79], v[8:11], v[168:171]
    v_mfma_f32_16x16x32_bf16 v[172:175], v[76:79], v[12:15], v[172:175]
    v_mfma_f32_16x16x32_bf16 v[176:179], v[76:79], v[16:19], v[176:179]
    v_mfma_f32_16x16x32_bf16 v[180:183], v[76:79], v[20:23], v[180:183]
    s_waitcnt vmcnt(16) lgkmcnt(0)
    v_mfma_f32_16x16x32_bf16 v[152:155], v[80:83], v[24:27], v[152:155]
    ds_read_b128 v[8:11], v214 offset:6144
    v_mfma_f32_16x16x32_bf16 v[156:159], v[80:83], v[28:31], v[156:159]
    ds_read_b128 v[12:15], v214 offset:20480
    v_mfma_f32_16x16x32_bf16 v[160:163], v[80:83], v[32:35], v[160:163]
    ds_read_b128 v[16:19], v214 offset:34816
    v_mfma_f32_16x16x32_bf16 v[164:167], v[80:83], v[36:39], v[164:167]
    ds_read_b128 v[20:23], v214 offset:49152
    v_mfma_f32_16x16x32_bf16 v[168:171], v[84:87], v[24:27], v[168:171]
    v_mfma_f32_16x16x32_bf16 v[172:175], v[84:87], v[28:31], v[172:175]
    v_mfma_f32_16x16x32_bf16 v[176:179], v[84:87], v[32:35], v[176:179]
    v_mfma_f32_16x16x32_bf16 v[180:183], v[84:87], v[36:39], v[180:183]
    s_waitcnt vmcnt(14) lgkmcnt(0)
    v_mfma_f32_16x16x32_bf16 v[152:155], v[88:91], v[8:11], v[152:155]
    ds_read_b128 v[24:27], v214 offset:7168
    v_mfma_f32_16x16x32_bf16 v[156:159], v[88:91], v[12:15], v[156:159]
    ds_read_b128 v[28:31], v214 offset:21504
    v_mfma_f32_16x16x32_bf16 v[160:163], v[88:91], v[16:19], v[160:163]
    ds_read_b128 v[32:35], v214 offset:35840
    v_mfma_f32_16x16x32_bf16 v[164:167], v[88:91], v[20:23], v[164:167]
    ds_read_b128 v[36:39], v214 offset:50176
    v_mfma_f32_16x16x32_bf16 v[168:171], v[92:95], v[8:11], v[168:171]
    v_mfma_f32_16x16x32_bf16 v[172:175], v[92:95], v[12:15], v[172:175]
    v_mfma_f32_16x16x32_bf16 v[176:179], v[92:95], v[16:19], v[176:179]
    v_mfma_f32_16x16x32_bf16 v[180:183], v[92:95], v[20:23], v[180:183]
    s_waitcnt vmcnt(12) lgkmcnt(0)
    v_mfma_f32_16x16x32_bf16 v[152:155], v[96:99], v[24:27], v[152:155]
    ds_read_b128 v[8:11], v214 offset:8192
    v_mfma_f32_16x16x32_bf16 v[156:159], v[96:99], v[28:31], v[156:159]
    ds_read_b128 v[12:15], v214 offset:22528
    v_mfma_f32_16x16x32_bf16 v[160:163], v[96:99], v[32:35], v[160:163]
    ds_read_b128 v[16:19], v214 offset:36864
    v_mfma_f32_16x16x32_bf16 v[164:167], v[96:99], v[36:39], v[164:167]
    ds_read_b128 v[20:23], v214 offset:51200
    v_mfma_f32_16x16x32_bf16 v[168:171], v[100:103], v[24:27], v[168:171]
    v_mfma_f32_16x16x32_bf16 v[172:175], v[100:103], v[28:31], v[172:175]
    v_mfma_f32_16x16x32_bf16 v[176:179], v[100:103], v[32:35], v[176:179]
    v_mfma_f32_16x16x32_bf16 v[180:183], v[100:103], v[36:39], v[180:183]
    s_waitcnt vmcnt(10) lgkmcnt(0)
    v_mfma_f32_16x16x32_bf16 v[152:155], v[104:107], v[8:11], v[152:155]
    ds_read_b128 v[24:27], v214 offset:9216
    v_mfma_f32_16x16x32_bf16 v[156:159], v[104:107], v[12:15], v[156:159]
    ds_read_b128 v[28:31], v214 offset:23552
    v_mfma_f32_16x16x32_bf16 v[160:163], v[104:107], v[16:19], v[160:163]
    ds_read_b128 v[32:35], v214 offset:37888
    v_mfma_f32_16x16x32_bf16 v[164:167], v[104:107], v[20:23], v[164:167]
    ds_read_b128 v[36:39], v214 offset:52224
    v_mfma_f32_16x16x32_bf16 v[168:171], v[108:111], v[8:11], v[168:171]
    v_mfma_f32_16x16x32_bf16 v[172:175], v[108:111], v[12:15], v[172:175]
    v_mfma_f32_16x16x32_bf16 v[176:179], v[108:111], v[16:19], v[176:179]
    v_mfma_f32_16x16x32_bf16 v[180:183], v[108:111], v[20:23], v[180:183]
    s_waitcnt vmcnt(8) lgkmcnt(0)
    v_mfma_f32_16x16x32_bf16 v[152:155], v[112:115], v[24:27], v[152:155]
    ds_read_b128 v[8:11], v214 offset:10240
    v_mfma_f32_16x16x32_bf16 v[156:159], v[112:115], v[28:31], v[156:159]
    ds_read_b128 v[12:15], v214 offset:24576
    v_mfma_f32_16x16x32_bf16 v[160:163], v[112:115], v[32:35], v[160:163]
    ds_read_b128 v[16:19], v214 offset:38912
    v_mfma_f32_16x16x32_bf16 v[164:167], v[112:115], v[36:39], v[164:167]
    ds_read_b128 v[20:23], v214 offset:53248
    v_mfma_f32_16x16x32_bf16 v[168:171], v[116:119], v[24:27], v[168:171]
    v_mfma_f32_16x16x32_bf16 v[172:175], v[116:119], v[28:31], v[172:175]
    v_mfma_f32_16x16x32_bf16 v[176:179], v[116:119], v[32:35], v[176:179]
    v_mfma_f32_16x16x32_bf16 v[180:183], v[116:119], v[36:39], v[180:183]
    s_waitcnt vmcnt(6) lgkmcnt(0)
    v_mfma_f32_16x16x32_bf16 v[152:155], v[120:123], v[8:11], v[152:155]
    ds_read_b128 v[24:27], v214 offset:11264
    v_mfma_f32_16x16x32_bf16 v[156:159], v[120:123], v[12:15], v[156:159]
    ds_read_b128 v[28:31], v214 offset:25600
    v_mfma_f32_16x16x32_bf16 v[160:163], v[120:123], v[16:19], v[160:163]
    ds_read_b128 v[32:35], v214 offset:39936
    v_mfma_f32_16x16x32_bf16 v[164:167], v[120:123], v[20:23], v[164:167]
    ds_read_b128 v[36:39], v214 offset:54272
    v_mfma_f32_16x16x32_bf16 v[168:171], v[124:127], v[8:11], v[168:171]
    v_mfma_f32_16x16x32_bf16 v[172:175], v[124:127], v[12:15], v[172:175]
    v_mfma_f32_16x16x32_bf16 v[176:179], v[124:127], v[16:19], v[176:179]
    v_mfma_f32_16x16x32_bf16 v[180:183], v[124:127], v[20:23], v[180:183]
    s_waitcnt vmcnt(4) lgkmcnt(0)
    v_mfma_f32_16x16x32_bf16 v[152:155], v[128:131], v[24:27], v[152:155]
    ds_read_b128 v[8:11], v214 offset:12288
    v_mfma_f32_16x16x32_bf16 v[156:159], v[128:131], v[28:31], v[156:159]
    ds_read_b128 v[12:15], v214 offset:26624
    v_mfma_f32_16x16x32_bf16 v[160:163], v[128:131], v[32:35], v[160:163]
    ds_read_b128 v[16:19], v214 offset:40960
    v_mfma_f32_16x16x32_bf16 v[164:167], v[128:131], v[36:39], v[164:167]
    ds_read_b128 v[20:23], v214 offset:55296
    v_mfma_f32_16x16x32_bf16 v[168:171], v[132:135], v[24:27], v[168:171]
    v_mfma_f32_16x16x32_bf16 v[172:175], v[132:135], v[28:31], v[172:175]
    v_mfma_f32_16x16x32_bf16 v[176:179], v[132:135], v[32:35], v[176:179]
    v_mfma_f32_16x16x32_bf16 v[180:183], v[132:135], v[36:39], v[180:183]
    s_waitcnt vmcnt(2) lgkmcnt(0)
    v_mfma_f32_16x16x32_bf16 v[152:155], v[136:139], v[8:11], v[152:155]
    ds_read_b128 v[24:27], v214 offset:13312
    v_mfma_f32_16x16x32_bf16 v[156:159], v[136:139], v[12:15], v[156:159]
    ds_read_b128 v[28:31], v214 offset:27648
    v_mfma_f32_16x16x32_bf16 v[160:163], v[136:139], v[16:19], v[160:163]
    ds_read_b128 v[32:35], v214 offset:41984
    v_mfma_f32_16x16x32_bf16 v[164:167], v[136:139], v[20:23], v[164:167]
    ds_read_b128 v[36:39], v214 offset:56320
    v_mfma_f32_16x16x32_bf16 v[168:171], v[140:143], v[8:11], v[168:171]
    v_mfma_f32_16x16x32_bf16 v[172:175], v[140:143], v[12:15], v[172:175]
    v_mfma_f32_16x16x32_bf16 v[176:179], v[140:143], v[16:19], v[176:179]
    v_mfma_f32_16x16x32_bf16 v[180:183], v[140:143], v[20:23], v[180:183]
    s_waitcnt vmcnt(0) lgkmcnt(0)
    v_mfma_f32_16x16x32_bf16 v[152:155], v[144:147], v[24:27], v[152:155]
    v_mfma_f32_16x16x32_bf16 v[156:159], v[144:147], v[28:31], v[156:159]
    v_mfma_f32_16x16x32_bf16 v[160:163], v[144:147], v[32:35], v[160:163]
    v_mfma_f32_16x16x32_bf16 v[164:167], v[144:147], v[36:39], v[164:167]
    v_mfma_f32_16x16x32_bf16 v[168:171], v[148:151], v[24:27], v[168:171]
    v_mfma_f32_16x16x32_bf16 v[172:175], v[148:151], v[28:31], v[172:175]
    v_mfma_f32_16x16x32_bf16 v[176:179], v[148:151], v[32:35], v[176:179]
    v_mfma_f32_16x16x32_bf16 v[180:183], v[148:151], v[36:39], v[180:183]
    v_add_u32 v5, 0, v6
    v_max_f32 v152, 0, v152
    v_max_f32 v153, 0, v153
    v_max_f32 v154, 0, v154
    v_max_f32 v155, 0, v155
    v_cvt_pk_bf16_f32 v40, v152, v153
    v_cvt_pk_bf16_f32 v41, v154, v155
    v_max_f32 v168, 0, v168
    v_max_f32 v169, 0, v169
    v_max_f32 v170, 0, v170
    v_max_f32 v171, 0, v171
    v_cvt_pk_bf16_f32 v42, v168, v169
    v_cvt_pk_bf16_f32 v43, v170, v171
    global_store_dwordx4 v5, v[40:43], s[32:33] sc1
    v_add_u32 v5, 57344, v6
    v_max_f32 v156, 0, v156
    v_max_f32 v157, 0, v157
    v_max_f32 v158, 0, v158
    v_max_f32 v159, 0, v159
    v_cvt_pk_bf16_f32 v44, v156, v157
    v_cvt_pk_bf16_f32 v45, v158, v159
    v_max_f32 v172, 0, v172
    v_max_f32 v173, 0, v173
    v_max_f32 v174, 0, v174
    v_max_f32 v175, 0, v175
    v_cvt_pk_bf16_f32 v46, v172, v173
    v_cvt_pk_bf16_f32 v47, v174, v175
    global_store_dwordx4 v5, v[44:47], s[32:33] sc1
    v_add_u32 v5, 114688, v6
    v_max_f32 v160, 0, v160
    v_max_f32 v161, 0, v161
    v_max_f32 v162, 0, v162
    v_max_f32 v163, 0, v163
    v_cvt_pk_bf16_f32 v48, v160, v161
    v_cvt_pk_bf16_f32 v49, v162, v163
    v_max_f32 v176, 0, v176
    v_max_f32 v177, 0, v177
    v_max_f32 v178, 0, v178
    v_max_f32 v179, 0, v179
    v_cvt_pk_bf16_f32 v50, v176, v177
    v_cvt_pk_bf16_f32 v51, v178, v179
    global_store_dwordx4 v5, v[48:51], s[32:33] sc1
    v_add_u32 v5, 172032, v6
    v_max_f32 v164, 0, v164
    v_max_f32 v165, 0, v165
    v_max_f32 v166, 0, v166
    v_max_f32 v167, 0, v167
    v_cvt_pk_bf16_f32 v52, v164, v165
    v_cvt_pk_bf16_f32 v53, v166, v167
    v_max_f32 v180, 0, v180
    v_max_f32 v181, 0, v181
    v_max_f32 v182, 0, v182
    v_max_f32 v183, 0, v183
    v_cvt_pk_bf16_f32 v54, v180, v181
    v_cvt_pk_bf16_f32 v55, v182, v183
    global_store_dwordx4 v5, v[52:55], s[32:33] sc1
    s_endpgm
K3_PF:
    s_sub_u32 s4, s2, 224
    s_lshr_b32 s4, s4, 3
    s_lshl_b32 s4, s4, 3
    s_add_u32 s4, s4, s3
    s_mul_i32 s4, s4, 50176
    s_add_u32 s4, s4, 18874368
    v_lshlrev_b32 v7, 4, v2
    v_add_u32 v7, s4, v7
    s_waitcnt lgkmcnt(0)
    global_load_dwordx4 v[8:11], v7, s[32:33] offset:0
    global_load_dwordx4 v[12:15], v7, s[32:33] offset:1024
    global_load_dwordx4 v[16:19], v7, s[32:33] offset:2048
    global_load_dwordx4 v[20:23], v7, s[32:33] offset:3072
    v_add_u32 v7, 4096, v7
    global_load_dwordx4 v[24:27], v7, s[32:33] offset:0
    global_load_dwordx4 v[28:31], v7, s[32:33] offset:1024
    global_load_dwordx4 v[32:35], v7, s[32:33] offset:2048
    global_load_dwordx4 v[36:39], v7, s[32:33] offset:3072
    v_add_u32 v7, 4096, v7
    global_load_dwordx4 v[40:43], v7, s[32:33] offset:0
    global_load_dwordx4 v[44:47], v7, s[32:33] offset:1024
    global_load_dwordx4 v[48:51], v7, s[32:33] offset:2048
    global_load_dwordx4 v[52:55], v7, s[32:33] offset:3072
    v_add_u32 v7, 4096, v7
    global_load_dwordx4 v[56:59], v7, s[32:33] offset:0
    global_load_dwordx4 v[60:63], v7, s[32:33] offset:1024
    global_load_dwordx4 v[64:67], v7, s[32:33] offset:2048
    global_load_dwordx4 v[68:71], v7, s[32:33] offset:3072
    v_add_u32 v7, 4096, v7
    global_load_dwordx4 v[72:75], v7, s[32:33] offset:0
    global_load_dwordx4 v[76:79], v7, s[32:33] offset:1024
    global_load_dwordx4 v[80:83], v7, s[32:33] offset:2048
    global_load_dwordx4 v[84:87], v7, s[32:33] offset:3072
    v_add_u32 v7, 4096, v7
    global_load_dwordx4 v[88:91], v7, s[32:33] offset:0
    global_load_dwordx4 v[92:95], v7, s[32:33] offset:1024
    global_load_dwordx4 v[96:99], v7, s[32:33] offset:2048
    global_load_dwordx4 v[100:103], v7, s[32:33] offset:3072
    v_add_u32 v7, 4096, v7
    s_waitcnt vmcnt(23)
    global_load_dwordx4 v[8:11], v7, s[32:33] offset:0
    s_waitcnt vmcnt(23)
    global_load_dwordx4 v[12:15], v7, s[32:33] offset:1024
    s_waitcnt vmcnt(23)
    global_load_dwordx4 v[16:19], v7, s[32:33] offset:2048
    s_waitcnt vmcnt(23)
    global_load_dwordx4 v[20:23], v7, s[32:33] offset:3072
    v_add_u32 v7, 4096, v7
    s_waitcnt vmcnt(23)
    global_load_dwordx4 v[24:27], v7, s[32:33] offset:0
    s_waitcnt vmcnt(23)
    global_load_dwordx4 v[28:31], v7, s[32:33] offset:1024
    s_waitcnt vmcnt(23)
    global_load_dwordx4 v[32:35], v7, s[32:33] offset:2048
    s_waitcnt vmcnt(23)
    global_load_dwordx4 v[36:39], v7, s[32:33] offset:3072
    v_add_u32 v7, 4096, v7
    s_waitcnt vmcnt(23)
    global_load_dwordx4 v[40:43], v7, s[32:33] offset:0
    s_waitcnt vmcnt(23)
    global_load_dwordx4 v[44:47], v7, s[32:33] offset:1024
    s_waitcnt vmcnt(23)
    global_load_dwordx4 v[48:51], v7, s[32:33] offset:2048
    s_waitcnt vmcnt(23)
    global_load_dwordx4 v[52:55], v7, s[32:33] offset:3072
    v_add_u32 v7, 4096, v7
    s_waitcnt vmcnt(23)
    global_load_dwordx4 v[56:59], v7, s[32:33] offset:0
    s_waitcnt vmcnt(23)
    global_load_dwordx4 v[60:63], v7, s[32:33] offset:1024
    s_waitcnt vmcnt(23)
    global_load_dwordx4 v[64:67], v7, s[32:33] offset:2048
    s_waitcnt vmcnt(23)
    global_load_dwordx4 v[68:71], v7, s[32:33] offset:3072
    v_add_u32 v7, 4096, v7
    s_waitcnt vmcnt(23)
    global_load_dwordx4 v[72:75], v7, s[32:33] offset:0
    s_waitcnt vmcnt(23)
    global_load_dwordx4 v[76:79], v7, s[32:33] offset:1024
    s_waitcnt vmcnt(23)
    global_load_dwordx4 v[80:83], v7, s[32:33] offset:2048
    s_waitcnt vmcnt(23)
    global_load_dwordx4 v[84:87], v7, s[32:33] offset:3072
    v_add_u32 v7, 4096, v7
    s_waitcnt vmcnt(23)
    global_load_dwordx4 v[88:91], v7, s[32:33] offset:0
    s_waitcnt vmcnt(23)
    global_load_dwordx4 v[92:95], v7, s[32:33] offset:1024
    s_waitcnt vmcnt(23)
    global_load_dwordx4 v[96:99], v7, s[32:33] offset:2048
    s_waitcnt vmcnt(23)
    global_load_dwordx4 v[100:103], v7, s[32:33] offset:3072
    v_add_u32 v7, 4096, v7
    s_waitcnt vmcnt(23)
    global_load_dwordx4 v[8:11], v7, s[32:33] offset:0
K3_END:
    s_endpgm
.section .rodata,"a"
.p2align 6
.amdhsa_kernel k3_kernel
  .amdhsa_next_free_vgpr 216
  .amdhsa_next_free_sgpr 40
  .amdhsa_accum_offset 216
  .amdhsa_group_segment_fixed_size 0
  .amdhsa_kernarg_size 120
  .amdhsa_user_sgpr_count 2
  .amdhsa_user_sgpr_kernarg_segment_ptr 1
  .amdhsa_system_sgpr_workgroup_id_x 1
.end_amdhsa_kernel
.text
.globl k4_kernel
.p2align 8
.type k4_kernel,@function
k4_kernel:

    s_cmp_ge_u32 s2, 256
    s_cbranch_scc1 K4_END
    s_load_dwordx2 s[32:33], s[0:1], 112
    s_load_dwordx2 s[34:35], s[0:1], 96
    v_lshrrev_b32 v1, 6, v0
    v_and_b32 v2, 63, v0
    v_readfirstlane_b32 s3, v1
    s_mov_b32 s15, 0xffff0000
    s_cmp_ge_u32 s2, 224
    s_cbranch_scc1 K4_PF
    s_and_b32 s4, s2, 7
    s_lshr_b32 s6, s2, 3
    s_mul_i32 s7, s6, 37
    s_lshr_b32 s7, s7, 8
    s_mul_i32 s8, s7, 7
    s_sub_u32 s5, s6, s8
    s_lshl_b32 s4, s4, 2
    s_add_u32 s4, s4, s7
    v_lshlrev_b32 v7, 4, v2
    s_cmp_ge_u32 s3, 4
    s_cbranch_scc1 K4_LD
    v_and_b32 v3, 15, v2
    v_lshrrev_b32 v4, 4, v2
    s_and_b32 s10, s3, 1
    s_lshr_b32 s11, s3, 1
    s_lshl_b32 s6, s4, 6
    s_lshl_b32 s7, s11, 5
    s_add_u32 s6, s6, s7
    v_add_u32 v8, s6, v3
    v_mul_u32_u24 v8, 896, v8
    v_lshl_add_u32 v8, v4, 4, v8
    s_lshl_b32 s6, s5, 7
    s_lshl_b32 s7, s10, 6
    s_add_u32 s6, s6, s7
    v_add_u32 v8, s6, v8
    v_add_u32 v9, 14336, v8
    v_add_u32 v10, 6291456, v8
    v_add_u32 v11, 6291456, v9
    s_lshl_b32 s6, s10, 13
    v_add_u32 v12, s6, v7
    s_lshl_b32 s6, s11, 13
    s_add_u32 s6, s6, 16384
    v_add_u32 v13, s6, v7
    v_add_u32 v14, 65536, v12
    v_add_u32 v15, 65536, v13
    v_add_u32 v56, 131072, v12
    v_add_u32 v57, 131072, v13
    s_waitcnt lgkmcnt(0)
    global_load_dwordx4 v[16:19], v10, s[32:33]
    global_load_dwordx4 v[20:23], v11, s[32:33]
    s_barrier
    ds_read_b128 v[24:27], v12 offset:0
    ds_read_b128 v[32:35], v13 offset:0
    ds_read_b128 v[28:31], v12 offset:4096
    ds_read_b128 v[36:39], v13 offset:4096
    s_waitcnt lgkmcnt(0)
    ds_read_b128 v[40:43], v12 offset:1024
    v_mfma_f32_16x16x32_bf16 v[64:67], v[24:27], v[32:35], 0
    ds_read_b128 v[48:51], v13 offset:1024
    v_mfma_f32_16x16x32_bf16 v[68:71], v[24:27], v[36:39], 0
    ds_read_b128 v[44:47], v12 offset:5120
    v_mfma_f32_16x16x32_bf16 v[72:75], v[28:31], v[32:35], 0
    ds_read_b128 v[52:55], v13 offset:5120
    v_mfma_f32_16x16x32_bf16 v[76:79], v[28:31], v[36:39], 0
    s_waitcnt lgkmcnt(0)
    ds_read_b128 v[24:27], v12 offset:2048
    v_mfma_f32_16x16x32_bf16 v[64:67], v[40:43], v[48:51], v[64:67]
    ds_read_b128 v[32:35], v13 offset:2048
    v_mfma_f32_16x16x32_bf16 v[68:71], v[40:43], v[52:55], v[68:71]
    ds_read_b128 v[28:31], v12 offset:6144
    v_mfma_f32_16x16x32_bf16 v[72:75], v[44:47], v[48:51], v[72:75]
    ds_read_b128 v[36:39], v13 offset:6144
    v_mfma_f32_16x16x32_bf16 v[76:79], v[44:47], v[52:55], v[76:79]
    s_waitcnt lgkmcnt(0)
    ds_read_b128 v[40:43], v12 offset:3072
    v_mfma_f32_16x16x32_bf16 v[64:67], v[24:27], v[32:35], v[64:67]
    ds_read_b128 v[48:51], v13 offset:3072
    v_mfma_f32_16x16x32_bf16 v[68:71], v[24:27], v[36:39], v[68:71]
    ds_read_b128 v[44:47], v12 offset:7168
    v_mfma_f32_16x16x32_bf16 v[72:75], v[28:31], v[32:35], v[72:75]
    ds_read_b128 v[52:55], v13 offset:7168
    v_mfma_f32_16x16x32_bf16 v[76:79], v[28:31], v[36:39], v[76:79]
    s_waitcnt lgkmcnt(0)
    v_mfma_f32_16x16x32_bf16 v[64:67], v[40:43], v[48:51], v[64:67]
    v_mfma_f32_16x16x32_bf16 v[68:71], v[40:43], v[52:55], v[68:71]
    v_mfma_f32_16x16x32_bf16 v[72:75], v[44:47], v[48:51], v[72:75]
    v_mfma_f32_16x16x32_bf16 v[76:79], v[44:47], v[52:55], v[76:79]
    s_barrier
    ds_read_b128 v[24:27], v12 offset:32768
    ds_read_b128 v[32:35], v13 offset:32768
    ds_read_b128 v[28:31], v12 offset:36864
    ds_read_b128 v[36:39], v13 offset:36864
    s_waitcnt lgkmcnt(0)
    ds_read_b128 v[40:43], v12 offset:33792
    v_mfma_f32_16x16x32_bf16 v[64:67], v[24:27], v[32:35], v[64:67]
    ds_read_b128 v[48:51], v13 offset:33792
    v_mfma_f32_16x16x32_bf16 v[68:71], v[24:27], v[36:39], v[68:71]
    ds_read_b128 v[44:47], v12 offset:37888
    v_mfma_f32_16x16x32_bf16 v[72:75], v[28:31], v[32:35], v[72:75]
    ds_read_b128 v[52:55], v13 offset:37888
    v_mfma_f32_16x16x32_bf16 v[76:79], v[28:31], v[36:39], v[76:79]
    s_waitcnt lgkmcnt(0)
    ds_read_b128 v[24:27], v12 offset:34816
    v_mfma_f32_16x16x32_bf16 v[64:67], v[40:43], v[48:51], v[64:67]
    ds_read_b128 v[32:35], v13 offset:34816
    v_mfma_f32_16x16x32_bf16 v[68:71], v[40:43], v[52:55], v[68:71]
    ds_read_b128 v[28:31], v12 offset:38912
    v_mfma_f32_16x16x32_bf16 v[72:75], v[44:47], v[48:51], v[72:75]
    ds_read_b128 v[36:39], v13 offset:38912
    v_mfma_f32_16x16x32_bf16 v[76:79], v[44:47], v[52:55], v[76:79]
    s_waitcnt lgkmcnt(0)
    ds_read_b128 v[40:43], v12 offset:35840
    v_mfma_f32_16x16x32_bf16 v[64:67], v[24:27], v[32:35], v[64:67]
    ds_read_b128 v[48:51], v13 offset:35840
    v_mfma_f32_16x16x32_bf16 v[68:71], v[24:27], v[36:39], v[68:71]
    ds_read_b128 v[44:47], v12 offset:39936
    v_mfma_f32_16x16x32_bf16 v[72:75], v[28:31], v[32:35], v[72:75]
    ds_read_b128 v[52:55], v13 offset:39936
    v_mfma_f32_16x16x32_bf16 v[76:79], v[28:31], v[36:39], v[76:79]
    s_waitcnt lgkmcnt(0)
    v_mfma_f32_16x16x32_bf16 v[64:67], v[40:43], v[48:51], v[64:67]
    v_mfma_f32_16x16x32_bf16 v[68:71], v[40:43], v[52:55], v[68:71]
    v_mfma_f32_16x16x32_bf16 v[72:75], v[44:47], v[48:51], v[72:75]
    v_mfma_f32_16x16x32_bf16 v[76:79], v[44:47], v[52:55], v[76:79]
    s_barrier
    ds_read_b128 v[24:27], v14 offset:0
    ds_read_b128 v[32:35], v15 offset:0
    ds_read_b128 v[28:31], v14 offset:4096
    ds_read_b128 v[36:39], v15 offset:4096
    s_waitcnt lgkmcnt(0)
    ds_read_b128 v[40:43], v14 offset:1024
    v_mfma_f32_16x16x32_bf16 v[64:67], v[24:27], v[32:35], v[64:67]
    ds_read_b128 v[48:51], v15 offset:1024
    v_mfma_f32_16x16x32_bf16 v[68:71], v[24:27], v[36:39], v[68:71]
    ds_read_b128 v[44:47], v14 offset:5120
    v_mfma_f32_16x16x32_bf16 v[72:75], v[28:31], v[32:35], v[72:75]
    ds_read_b128 v[52:55], v15 offset:5120
    v_mfma_f32_16x16x32_bf16 v[76:79], v[28:31], v[36:39], v[76:79]
    s_waitcnt lgkmcnt(0)
    ds_read_b128 v[24:27], v14 offset:2048
    v_mfma_f32_16x16x32_bf16 v[64:67], v[40:43], v[48:51], v[64:67]
    ds_read_b128 v[32:35], v15 offset:2048
    v_mfma_f32_16x16x32_bf16 v[68:71], v[40:43], v[52:55], v[68:71]
    ds_read_b128 v[28:31], v14 offset:6144
    v_mfma_f32_16x16x32_bf16 v[72:75], v[44:47], v[48:51], v[72:75]
    ds_read_b128 v[36:39], v15 offset:6144
    v_mfma_f32_16x16x32_bf16 v[76:79], v[44:47], v[52:55], v[76:79]
    s_waitcnt lgkmcnt(0)
    ds_read_b128 v[40:43], v14 offset:3072
    v_mfma_f32_16x16x32_bf16 v[64:67], v[24:27], v[32:35], v[64:67]
    ds_read_b128 v[48:51], v15 offset:3072
    v_mfma_f32_16x16x32_bf16 v[68:71], v[24:27], v[36:39], v[68:71]
    ds_read_b128 v[44:47], v14 offset:7168
    v_mfma_f32_16x16x32_bf16 v[72:75], v[28:31], v[32:35], v[72:75]
    ds_read_b128 v[52:55], v15 offset:7168
    v_mfma_f32_16x16x32_bf16 v[76:79], v[28:31], v[36:39], v[76:79]
    s_waitcnt lgkmcnt(0)
    v_mfma_f32_16x16x32_bf16 v[64:67], v[40:43], v[48:51], v[64:67]
    v_mfma_f32_16x16x32_bf16 v[68:71], v[40:43], v[52:55], v[68:71]
    v_mfma_f32_16x16x32_bf16 v[72:75], v[44:47], v[48:51], v[72:75]
    v_mfma_f32_16x16x32_bf16 v[76:79], v[44:47], v[52:55], v[76:79]
    s_barrier
    ds_read_b128 v[24:27], v14 offset:32768
    ds_read_b128 v[32:35], v15 offset:32768
    ds_read_b128 v[28:31], v14 offset:36864
    ds_read_b128 v[36:39], v15 offset:36864
    s_waitcnt lgkmcnt(0)
    ds_read_b128 v[40:43], v14 offset:33792
    v_mfma_f32_16x16x32_bf16 v[64:67], v[24:27], v[32:35], v[64:67]
    ds_read_b128 v[48:51], v15 offset:33792
    v_mfma_f32_16x16x32_bf16 v[68:71], v[24:27], v[36:39], v[68:71]
    ds_read_b128 v[44:47], v14 offset:37888
    v_mfma_f32_16x16x32_bf16 v[72:75], v[28:31], v[32:35], v[72:75]
    ds_read_b128 v[52:55], v15 offset:37888
    v_mfma_f32_16x16x32_bf16 v[76:79], v[28:31], v[36:39], v[76:79]
    s_waitcnt lgkmcnt(0)
    ds_read_b128 v[24:27], v14 offset:34816
    v_mfma_f32_16x16x32_bf16 v[64:67], v[40:43], v[48:51], v[64:67]
    ds_read_b128 v[32:35], v15 offset:34816
    v_mfma_f32_16x16x32_bf16 v[68:71], v[40:43], v[52:55], v[68:71]
    ds_read_b128 v[28:31], v14 offset:38912
    v_mfma_f32_16x16x32_bf16 v[72:75], v[44:47], v[48:51], v[72:75]
    ds_read_b128 v[36:39], v15 offset:38912
    v_mfma_f32_16x16x32_bf16 v[76:79], v[44:47], v[52:55], v[76:79]
    s_waitcnt lgkmcnt(0)
    ds_read_b128 v[40:43], v14 offset:35840
    v_mfma_f32_16x16x32_bf16 v[64:67], v[24:27], v[32:35], v[64:67]
    ds_read_b128 v[48:51], v15 offset:35840
    v_mfma_f32_16x16x32_bf16 v[68:71], v[24:27], v[36:39], v[68:71]
    ds_read_b128 v[44:47], v14 offset:39936
    v_mfma_f32_16x16x32_bf16 v[72:75], v[28:31], v[32:35], v[72:75]
    ds_read_b128 v[52:55], v15 offset:39936
    v_mfma_f32_16x16x32_bf16 v[76:79], v[28:31], v[36:39], v[76:79]
    s_waitcnt lgkmcnt(0)
    v_mfma_f32_16x16x32_bf16 v[64:67], v[40:43], v[48:51], v[64:67]
    v_mfma_f32_16x16x32_bf16 v[68:71], v[40:43], v[52:55], v[68:71]
    v_mfma_f32_16x16x32_bf16 v[72:75], v[44:47], v[48:51], v[72:75]
    v_mfma_f32_16x16x32_bf16 v[76:79], v[44:47], v[52:55], v[76:79]
    s_barrier
    ds_read_b128 v[24:27], v56 offset:0
    ds_read_b128 v[32:35], v57 offset:0
    ds_read_b128 v[28:31], v56 offset:4096
    ds_read_b128 v[36:39], v57 offset:4096
    s_waitcnt lgkmcnt(0)
    ds_read_b128 v[40:43], v56 offset:1024
    v_mfma_f32_16x16x32_bf16 v[64:67], v[24:27], v[32:35], v[64:67]
    ds_read_b128 v[48:51], v57 offset:1024
    v_mfma_f32_16x16x32_bf16 v[68:71], v[24:27], v[36:39], v[68:71]
    ds_read_b128 v[44:47], v56 offset:5120
    v_mfma_f32_16x16x32_bf16 v[72:75], v[28:31], v[32:35], v[72:75]
    ds_read_b128 v[52:55], v57 offset:5120
    v_mfma_f32_16x16x32_bf16 v[76:79], v[28:31], v[36:39], v[76:79]
    s_waitcnt lgkmcnt(0)
    ds_read_b128 v[24:27], v56 offset:2048
    v_mfma_f32_16x16x32_bf16 v[64:67], v[40:43], v[48:51], v[64:67]
    ds_read_b128 v[32:35], v57 offset:2048
    v_mfma_f32_16x16x32_bf16 v[68:71], v[40:43], v[52:55], v[68:71]
    ds_read_b128 v[28:31], v56 offset:6144
    v_mfma_f32_16x16x32_bf16 v[72:75], v[44:47], v[48:51], v[72:75]
    ds_read_b128 v[36:39], v57 offset:6144
    v_mfma_f32_16x16x32_bf16 v[76:79], v[44:47], v[52:55], v[76:79]
    s_waitcnt lgkmcnt(0)
    ds_read_b128 v[40:43], v56 offset:3072
    v_mfma_f32_16x16x32_bf16 v[64:67], v[24:27], v[32:35], v[64:67]
    ds_read_b128 v[48:51], v57 offset:3072
    v_mfma_f32_16x16x32_bf16 v[68:71], v[24:27], v[36:39], v[68:71]
    ds_read_b128 v[44:47], v56 offset:7168
    v_mfma_f32_16x16x32_bf16 v[72:75], v[28:31], v[32:35], v[72:75]
    ds_read_b128 v[52:55], v57 offset:7168
    v_mfma_f32_16x16x32_bf16 v[76:79], v[28:31], v[36:39], v[76:79]
    s_waitcnt lgkmcnt(0)
    v_mfma_f32_16x16x32_bf16 v[64:67], v[40:43], v[48:51], v[64:67]
    v_mfma_f32_16x16x32_bf16 v[68:71], v[40:43], v[52:55], v[68:71]
    v_mfma_f32_16x16x32_bf16 v[72:75], v[44:47], v[48:51], v[72:75]
    v_mfma_f32_16x16x32_bf16 v[76:79], v[44:47], v[52:55], v[76:79]
    s_barrier
    ds_read_b128 v[24:27], v12 offset:0
    ds_read_b128 v[32:35], v13 offset:0
    ds_read_b128 v[28:31], v12 offset:4096
    ds_read_b128 v[36:39], v13 offset:4096
    s_waitcnt lgkmcnt(0)
    ds_read_b128 v[40:43], v12 offset:1024
    v_mfma_f32_16x16x32_bf16 v[64:67], v[24:27], v[32:35], v[64:67]
    ds_read_b128 v[48:51], v13 offset:1024
    v_mfma_f32_16x16x32_bf16 v[68:71], v[24:27], v[36:39], v[68:71]
    ds_read_b128 v[44:47], v12 offset:5120
    v_mfma_f32_16x16x32_bf16 v[72:75], v[28:31], v[32:35], v[72:75]
    ds_read_b128 v[52:55], v13 offset:5120
    v_mfma_f32_16x16x32_bf16 v[76:79], v[28:31], v[36:39], v[76:79]
    s_waitcnt lgkmcnt(0)
    ds_read_b128 v[24:27], v12 offset:2048
    v_mfma_f32_16x16x32_bf16 v[64:67], v[40:43], v[48:51], v[64:67]
    ds_read_b128 v[32:35], v13 offset:2048
    v_mfma_f32_16x16x32_bf16 v[68:71], v[40:43], v[52:55], v[68:71]
    ds_read_b128 v[28:31], v12 offset:6144
    v_mfma_f32_16x16x32_bf16 v[72:75], v[44:47], v[48:51], v[72:75]
    ds_read_b128 v[36:39], v13 offset:6144
    v_mfma_f32_16x16x32_bf16 v[76:79], v[44:47], v[52:55], v[76:79]
    s_waitcnt lgkmcnt(0)
    ds_read_b128 v[40:43], v12 offset:3072
    v_mfma_f32_16x16x32_bf16 v[64:67], v[24:27], v[32:35], v[64:67]
    ds_read_b128 v[48:51], v13 offset:3072
    v_mfma_f32_16x16x32_bf16 v[68:71], v[24:27], v[36:39], v[68:71]
    ds_read_b128 v[44:47], v12 offset:7168
    v_mfma_f32_16x16x32_bf16 v[72:75], v[28:31], v[32:35], v[72:75]
    ds_read_b128 v[52:55], v13 offset:7168
    v_mfma_f32_16x16x32_bf16 v[76:79], v[28:31], v[36:39], v[76:79]
    s_waitcnt lgkmcnt(0)
    v_mfma_f32_16x16x32_bf16 v[64:67], v[40:43], v[48:51], v[64:67]
    v_mfma_f32_16x16x32_bf16 v[68:71], v[40:43], v[52:55], v[68:71]
    v_mfma_f32_16x16x32_bf16 v[72:75], v[44:47], v[48:51], v[72:75]
    v_mfma_f32_16x16x32_bf16 v[76:79], v[44:47], v[52:55], v[76:79]
    s_barrier
    ds_read_b128 v[24:27], v12 offset:32768
    ds_read_b128 v[32:35], v13 offset:32768
    ds_read_b128 v[28:31], v12 offset:36864
    ds_read_b128 v[36:39], v13 offset:36864
    s_waitcnt lgkmcnt(0)
    ds_read_b128 v[40:43], v12 offset:33792
    v_mfma_f32_16x16x32_bf16 v[64:67], v[24:27], v[32:35], v[64:67]
    ds_read_b128 v[48:51], v13 offset:33792
    v_mfma_f32_16x16x32_bf16 v[68:71], v[24:27], v[36:39], v[68:71]
    ds_read_b128 v[44:47], v12 offset:37888
    v_mfma_f32_16x16x32_bf16 v[72:75], v[28:31], v[32:35], v[72:75]
    ds_read_b128 v[52:55], v13 offset:37888
    v_mfma_f32_16x16x32_bf16 v[76:79], v[28:31], v[36:39], v[76:79]
    s_waitcnt lgkmcnt(0)
    ds_read_b128 v[24:27], v12 offset:34816
    v_mfma_f32_16x16x32_bf16 v[64:67], v[40:43], v[48:51], v[64:67]
    ds_read_b128 v[32:35], v13 offset:34816
    v_mfma_f32_16x16x32_bf16 v[68:71], v[40:43], v[52:55], v[68:71]
    ds_read_b128 v[28:31], v12 offset:38912
    v_mfma_f32_16x16x32_bf16 v[72:75], v[44:47], v[48:51], v[72:75]
    ds_read_b128 v[36:39], v13 offset:38912
    v_mfma_f32_16x16x32_bf16 v[76:79], v[44:47], v[52:55], v[76:79]
    s_waitcnt lgkmcnt(0)
    ds_read_b128 v[40:43], v12 offset:35840
    v_mfma_f32_16x16x32_bf16 v[64:67], v[24:27], v[32:35], v[64:67]
    ds_read_b128 v[48:51], v13 offset:35840
    v_mfma_f32_16x16x32_bf16 v[68:71], v[24:27], v[36:39], v[68:71]
    ds_read_b128 v[44:47], v12 offset:39936
    v_mfma_f32_16x16x32_bf16 v[72:75], v[28:31], v[32:35], v[72:75]
    ds_read_b128 v[52:55], v13 offset:39936
    v_mfma_f32_16x16x32_bf16 v[76:79], v[28:31], v[36:39], v[76:79]
    s_waitcnt lgkmcnt(0)
    v_mfma_f32_16x16x32_bf16 v[64:67], v[40:43], v[48:51], v[64:67]
    v_mfma_f32_16x16x32_bf16 v[68:71], v[40:43], v[52:55], v[68:71]
    v_mfma_f32_16x16x32_bf16 v[72:75], v[44:47], v[48:51], v[72:75]
    v_mfma_f32_16x16x32_bf16 v[76:79], v[44:47], v[52:55], v[76:79]
    s_barrier
    ds_read_b128 v[24:27], v14 offset:0
    ds_read_b128 v[32:35], v15 offset:0
    ds_read_b128 v[28:31], v14 offset:4096
    ds_read_b128 v[36:39], v15 offset:4096
    s_waitcnt lgkmcnt(0)
    ds_read_b128 v[40:43], v14 offset:1024
    v_mfma_f32_16x16x32_bf16 v[64:67], v[24:27], v[32:35], v[64:67]
    ds_read_b128 v[48:51], v15 offset:1024
    v_mfma_f32_16x16x32_bf16 v[68:71], v[24:27], v[36:39], v[68:71]
    ds_read_b128 v[44:47], v14 offset:5120
    v_mfma_f32_16x16x32_bf16 v[72:75], v[28:31], v[32:35], v[72:75]
    ds_read_b128 v[52:55], v15 offset:5120
    v_mfma_f32_16x16x32_bf16 v[76:79], v[28:31], v[36:39], v[76:79]
    s_waitcnt lgkmcnt(0)
    ds_read_b128 v[24:27], v14 offset:2048
    v_mfma_f32_16x16x32_bf16 v[64:67], v[40:43], v[48:51], v[64:67]
    ds_read_b128 v[32:35], v15 offset:2048
    v_mfma_f32_16x16x32_bf16 v[68:71], v[40:43], v[52:55], v[68:71]
    ds_read_b128 v[28:31], v14 offset:6144
    v_mfma_f32_16x16x32_bf16 v[72:75], v[44:47], v[48:51], v[72:75]
    ds_read_b128 v[36:39], v15 offset:6144
    v_mfma_f32_16x16x32_bf16 v[76:79], v[44:47], v[52:55], v[76:79]
    s_waitcnt lgkmcnt(0)
    ds_read_b128 v[40:43], v14 offset:3072
    v_mfma_f32_16x16x32_bf16 v[64:67], v[24:27], v[32:35], v[64:67]
    ds_read_b128 v[48:51], v15 offset:3072
    v_mfma_f32_16x16x32_bf16 v[68:71], v[24:27], v[36:39], v[68:71]
    ds_read_b128 v[44:47], v14 offset:7168
    v_mfma_f32_16x16x32_bf16 v[72:75], v[28:31], v[32:35], v[72:75]
    ds_read_b128 v[52:55], v15 offset:7168
    v_mfma_f32_16x16x32_bf16 v[76:79], v[28:31], v[36:39], v[76:79]
    s_waitcnt lgkmcnt(0)
    v_mfma_f32_16x16x32_bf16 v[64:67], v[40:43], v[48:51], v[64:67]
    v_mfma_f32_16x16x32_bf16 v[68:71], v[40:43], v[52:55], v[68:71]
    v_mfma_f32_16x16x32_bf16 v[72:75], v[44:47], v[48:51], v[72:75]
    v_mfma_f32_16x16x32_bf16 v[76:79], v[44:47], v[52:55], v[76:79]
    s_barrier
    ds_read_b128 v[24:27], v14 offset:32768
    ds_read_b128 v[32:35], v15 offset:32768
    ds_read_b128 v[28:31], v14 offset:36864
    ds_read_b128 v[36:39], v15 offset:36864
    s_waitcnt lgkmcnt(0)
    ds_read_b128 v[40:43], v14 offset:33792
    v_mfma_f32_16x16x32_bf16 v[64:67], v[24:27], v[32:35], v[64:67]
    ds_read_b128 v[48:51], v15 offset:33792
    v_mfma_f32_16x16x32_bf16 v[68:71], v[24:27], v[36:39], v[68:71]
    ds_read_b128 v[44:47], v14 offset:37888
    v_mfma_f32_16x16x32_bf16 v[72:75], v[28:31], v[32:35], v[72:75]
    ds_read_b128 v[52:55], v15 offset:37888
    v_mfma_f32_16x16x32_bf16 v[76:79], v[28:31], v[36:39], v[76:79]
    s_waitcnt lgkmcnt(0)
    ds_read_b128 v[24:27], v14 offset:34816
    v_mfma_f32_16x16x32_bf16 v[64:67], v[40:43], v[48:51], v[64:67]
    ds_read_b128 v[32:35], v15 offset:34816
    v_mfma_f32_16x16x32_bf16 v[68:71], v[40:43], v[52:55], v[68:71]
    ds_read_b128 v[28:31], v14 offset:38912
    v_mfma_f32_16x16x32_bf16 v[72:75], v[44:47], v[48:51], v[72:75]
    ds_read_b128 v[36:39], v15 offset:38912
    v_mfma_f32_16x16x32_bf16 v[76:79], v[44:47], v[52:55], v[76:79]
    s_waitcnt lgkmcnt(0)
    ds_read_b128 v[40:43], v14 offset:35840
    v_mfma_f32_16x16x32_bf16 v[64:67], v[24:27], v[32:35], v[64:67]
    ds_read_b128 v[48:51], v15 offset:35840
    v_mfma_f32_16x16x32_bf16 v[68:71], v[24:27], v[36:39], v[68:71]
    ds_read_b128 v[44:47], v14 offset:39936
    v_mfma_f32_16x16x32_bf16 v[72:75], v[28:31], v[32:35], v[72:75]
    ds_read_b128 v[52:55], v15 offset:39936
    v_mfma_f32_16x16x32_bf16 v[76:79], v[28:31], v[36:39], v[76:79]
    s_waitcnt lgkmcnt(0)
    v_mfma_f32_16x16x32_bf16 v[64:67], v[40:43], v[48:51], v[64:67]
    v_mfma_f32_16x16x32_bf16 v[68:71], v[40:43], v[52:55], v[68:71]
    v_mfma_f32_16x16x32_bf16 v[72:75], v[44:47], v[48:51], v[72:75]
    v_mfma_f32_16x16x32_bf16 v[76:79], v[44:47], v[52:55], v[76:79]
    s_barrier
    ds_read_b128 v[24:27], v56 offset:0
    ds_read_b128 v[32:35], v57 offset:0
    ds_read_b128 v[28:31], v56 offset:4096
    ds_read_b128 v[36:39], v57 offset:4096
    s_waitcnt lgkmcnt(0)
    ds_read_b128 v[40:43], v56 offset:1024
    v_mfma_f32_16x16x32_bf16 v[64:67], v[24:27], v[32:35], v[64:67]
    ds_read_b128 v[48:51], v57 offset:1024
    v_mfma_f32_16x16x32_bf16 v[68:71], v[24:27], v[36:39], v[68:71]
    ds_read_b128 v[44:47], v56 offset:5120
    v_mfma_f32_16x16x32_bf16 v[72:75], v[28:31], v[32:35], v[72:75]
    ds_read_b128 v[52:55], v57 offset:5120
    v_mfma_f32_16x16x32_bf16 v[76:79], v[28:31], v[36:39], v[76:79]
    s_waitcnt lgkmcnt(0)
    ds_read_b128 v[24:27], v56 offset:2048
    v_mfma_f32_16x16x32_bf16 v[64:67], v[40:43], v[48:51], v[64:67]
    ds_read_b128 v[32:35], v57 offset:2048
    v_mfma_f32_16x16x32_bf16 v[68:71], v[40:43], v[52:55], v[68:71]
    ds_read_b128 v[28:31], v56 offset:6144
    v_mfma_f32_16x16x32_bf16 v[72:75], v[44:47], v[48:51], v[72:75]
    ds_read_b128 v[36:39], v57 offset:6144
    v_mfma_f32_16x16x32_bf16 v[76:79], v[44:47], v[52:55], v[76:79]
    s_waitcnt lgkmcnt(0)
    ds_read_b128 v[40:43], v56 offset:3072
    v_mfma_f32_16x16x32_bf16 v[64:67], v[24:27], v[32:35], v[64:67]
    ds_read_b128 v[48:51], v57 offset:3072
    v_mfma_f32_16x16x32_bf16 v[68:71], v[24:27], v[36:39], v[68:71]
    ds_read_b128 v[44:47], v56 offset:7168
    v_mfma_f32_16x16x32_bf16 v[72:75], v[28:31], v[32:35], v[72:75]
    ds_read_b128 v[52:55], v57 offset:7168
    v_mfma_f32_16x16x32_bf16 v[76:79], v[28:31], v[36:39], v[76:79]
    s_waitcnt lgkmcnt(0)
    v_mfma_f32_16x16x32_bf16 v[64:67], v[40:43], v[48:51], v[64:67]
    v_mfma_f32_16x16x32_bf16 v[68:71], v[40:43], v[52:55], v[68:71]
    v_mfma_f32_16x16x32_bf16 v[72:75], v[44:47], v[48:51], v[72:75]
    v_mfma_f32_16x16x32_bf16 v[76:79], v[44:47], v[52:55], v[76:79]
    s_barrier
    ds_read_b128 v[24:27], v12 offset:0
    ds_read_b128 v[32:35], v13 offset:0
    ds_read_b128 v[28:31], v12 offset:4096
    ds_read_b128 v[36:39], v13 offset:4096
    s_waitcnt lgkmcnt(0)
    ds_read_b128 v[40:43], v12 offset:1024
    v_mfma_f32_16x16x32_bf16 v[64:67], v[24:27], v[32:35], v[64:67]
    ds_read_b128 v[48:51], v13 offset:1024
    v_mfma_f32_16x16x32_bf16 v[68:71], v[24:27], v[36:39], v[68:71]
    ds_read_b128 v[44:47], v12 offset:5120
    v_mfma_f32_16x16x32_bf16 v[72:75], v[28:31], v[32:35], v[72:75]
    ds_read_b128 v[52:55], v13 offset:5120
    v_mfma_f32_16x16x32_bf16 v[76:79], v[28:31], v[36:39], v[76:79]
    s_waitcnt lgkmcnt(0)
    ds_read_b128 v[24:27], v12 offset:2048
    v_mfma_f32_16x16x32_bf16 v[64:67], v[40:43], v[48:51], v[64:67]
    ds_read_b128 v[32:35], v13 offset:2048
    v_mfma_f32_16x16x32_bf16 v[68:71], v[40:43], v[52:55], v[68:71]
    ds_read_b128 v[28:31], v12 offset:6144
    v_mfma_f32_16x16x32_bf16 v[72:75], v[44:47], v[48:51], v[72:75]
    ds_read_b128 v[36:39], v13 offset:6144
    v_mfma_f32_16x16x32_bf16 v[76:79], v[44:47], v[52:55], v[76:79]
    s_waitcnt lgkmcnt(0)
    ds_read_b128 v[40:43], v12 offset:3072
    v_mfma_f32_16x16x32_bf16 v[64:67], v[24:27], v[32:35], v[64:67]
    ds_read_b128 v[48:51], v13 offset:3072
    v_mfma_f32_16x16x32_bf16 v[68:71], v[24:27], v[36:39], v[68:71]
    ds_read_b128 v[44:47], v12 offset:7168
    v_mfma_f32_16x16x32_bf16 v[72:75], v[28:31], v[32:35], v[72:75]
    ds_read_b128 v[52:55], v13 offset:7168
    v_mfma_f32_16x16x32_bf16 v[76:79], v[28:31], v[36:39], v[76:79]
    s_waitcnt lgkmcnt(0)
    v_mfma_f32_16x16x32_bf16 v[64:67], v[40:43], v[48:51], v[64:67]
    v_mfma_f32_16x16x32_bf16 v[68:71], v[40:43], v[52:55], v[68:71]
    v_mfma_f32_16x16x32_bf16 v[72:75], v[44:47], v[48:51], v[72:75]
    v_mfma_f32_16x16x32_bf16 v[76:79], v[44:47], v[52:55], v[76:79]
    s_barrier
    ds_read_b128 v[24:27], v12 offset:32768
    ds_read_b128 v[32:35], v13 offset:32768
    ds_read_b128 v[28:31], v12 offset:36864
    ds_read_b128 v[36:39], v13 offset:36864
    s_waitcnt lgkmcnt(0)
    ds_read_b128 v[40:43], v12 offset:33792
    v_mfma_f32_16x16x32_bf16 v[64:67], v[24:27], v[32:35], v[64:67]
    ds_read_b128 v[48:51], v13 offset:33792
    v_mfma_f32_16x16x32_bf16 v[68:71], v[24:27], v[36:39], v[68:71]
    ds_read_b128 v[44:47], v12 offset:37888
    v_mfma_f32_16x16x32_bf16 v[72:75], v[28:31], v[32:35], v[72:75]
    ds_read_b128 v[52:55], v13 offset:37888
    v_mfma_f32_16x16x32_bf16 v[76:79], v[28:31], v[36:39], v[76:79]
    s_waitcnt lgkmcnt(0)
    ds_read_b128 v[24:27], v12 offset:34816
    v_mfma_f32_16x16x32_bf16 v[64:67], v[40:43], v[48:51], v[64:67]
    ds_read_b128 v[32:35], v13 offset:34816
    v_mfma_f32_16x16x32_bf16 v[68:71], v[40:43], v[52:55], v[68:71]
    ds_read_b128 v[28:31], v12 offset:38912
    v_mfma_f32_16x16x32_bf16 v[72:75], v[44:47], v[48:51], v[72:75]
    ds_read_b128 v[36:39], v13 offset:38912
    v_mfma_f32_16x16x32_bf16 v[76:79], v[44:47], v[52:55], v[76:79]
    s_waitcnt lgkmcnt(0)
    ds_read_b128 v[40:43], v12 offset:35840
    v_mfma_f32_16x16x32_bf16 v[64:67], v[24:27], v[32:35], v[64:67]
    ds_read_b128 v[48:51], v13 offset:35840
    v_mfma_f32_16x16x32_bf16 v[68:71], v[24:27], v[36:39], v[68:71]
    ds_read_b128 v[44:47], v12 offset:39936
    v_mfma_f32_16x16x32_bf16 v[72:75], v[28:31], v[32:35], v[72:75]
    ds_read_b128 v[52:55], v13 offset:39936
    v_mfma_f32_16x16x32_bf16 v[76:79], v[28:31], v[36:39], v[76:79]
    s_waitcnt lgkmcnt(0)
    v_mfma_f32_16x16x32_bf16 v[64:67], v[40:43], v[48:51], v[64:67]
    v_mfma_f32_16x16x32_bf16 v[68:71], v[40:43], v[52:55], v[68:71]
    v_mfma_f32_16x16x32_bf16 v[72:75], v[44:47], v[48:51], v[72:75]
    v_mfma_f32_16x16x32_bf16 v[76:79], v[44:47], v[52:55], v[76:79]
    s_barrier
    ds_read_b128 v[24:27], v14 offset:0
    ds_read_b128 v[32:35], v15 offset:0
    ds_read_b128 v[28:31], v14 offset:4096
    ds_read_b128 v[36:39], v15 offset:4096
    s_waitcnt lgkmcnt(0)
    ds_read_b128 v[40:43], v14 offset:1024
    v_mfma_f32_16x16x32_bf16 v[64:67], v[24:27], v[32:35], v[64:67]
    ds_read_b128 v[48:51], v15 offset:1024
    v_mfma_f32_16x16x32_bf16 v[68:71], v[24:27], v[36:39], v[68:71]
    ds_read_b128 v[44:47], v14 offset:5120
    v_mfma_f32_16x16x32_bf16 v[72:75], v[28:31], v[32:35], v[72:75]
    ds_read_b128 v[52:55], v15 offset:5120
    v_mfma_f32_16x16x32_bf16 v[76:79], v[28:31], v[36:39], v[76:79]
    s_waitcnt lgkmcnt(0)
    ds_read_b128 v[24:27], v14 offset:2048
    v_mfma_f32_16x16x32_bf16 v[64:67], v[40:43], v[48:51], v[64:67]
    ds_read_b128 v[32:35], v15 offset:2048
    v_mfma_f32_16x16x32_bf16 v[68:71], v[40:43], v[52:55], v[68:71]
    ds_read_b128 v[28:31], v14 offset:6144
    v_mfma_f32_16x16x32_bf16 v[72:75], v[44:47], v[48:51], v[72:75]
    ds_read_b128 v[36:39], v15 offset:6144
    v_mfma_f32_16x16x32_bf16 v[76:79], v[44:47], v[52:55], v[76:79]
    s_waitcnt lgkmcnt(0)
    ds_read_b128 v[40:43], v14 offset:3072
    v_mfma_f32_16x16x32_bf16 v[64:67], v[24:27], v[32:35], v[64:67]
    ds_read_b128 v[48:51], v15 offset:3072
    v_mfma_f32_16x16x32_bf16 v[68:71], v[24:27], v[36:39], v[68:71]
    ds_read_b128 v[44:47], v14 offset:7168
    v_mfma_f32_16x16x32_bf16 v[72:75], v[28:31], v[32:35], v[72:75]
    ds_read_b128 v[52:55], v15 offset:7168
    v_mfma_f32_16x16x32_bf16 v[76:79], v[28:31], v[36:39], v[76:79]
    s_waitcnt lgkmcnt(0)
    v_mfma_f32_16x16x32_bf16 v[64:67], v[40:43], v[48:51], v[64:67]
    v_mfma_f32_16x16x32_bf16 v[68:71], v[40:43], v[52:55], v[68:71]
    v_mfma_f32_16x16x32_bf16 v[72:75], v[44:47], v[48:51], v[72:75]
    v_mfma_f32_16x16x32_bf16 v[76:79], v[44:47], v[52:55], v[76:79]
    s_barrier
    ds_read_b128 v[24:27], v14 offset:32768
    ds_read_b128 v[32:35], v15 offset:32768
    ds_read_b128 v[28:31], v14 offset:36864
    ds_read_b128 v[36:39], v15 offset:36864
    s_waitcnt lgkmcnt(0)
    ds_read_b128 v[40:43], v14 offset:33792
    v_mfma_f32_16x16x32_bf16 v[64:67], v[24:27], v[32:35], v[64:67]
    ds_read_b128 v[48:51], v15 offset:33792
    v_mfma_f32_16x16x32_bf16 v[68:71], v[24:27], v[36:39], v[68:71]
    ds_read_b128 v[44:47], v14 offset:37888
    v_mfma_f32_16x16x32_bf16 v[72:75], v[28:31], v[32:35], v[72:75]
    ds_read_b128 v[52:55], v15 offset:37888
    v_mfma_f32_16x16x32_bf16 v[76:79], v[28:31], v[36:39], v[76:79]
    s_waitcnt lgkmcnt(0)
    ds_read_b128 v[24:27], v14 offset:34816
    v_mfma_f32_16x16x32_bf16 v[64:67], v[40:43], v[48:51], v[64:67]
    ds_read_b128 v[32:35], v15 offset:34816
    v_mfma_f32_16x16x32_bf16 v[68:71], v[40:43], v[52:55], v[68:71]
    ds_read_b128 v[28:31], v14 offset:38912
    v_mfma_f32_16x16x32_bf16 v[72:75], v[44:47], v[48:51], v[72:75]
    ds_read_b128 v[36:39], v15 offset:38912
    v_mfma_f32_16x16x32_bf16 v[76:79], v[44:47], v[52:55], v[76:79]
    s_waitcnt lgkmcnt(0)
    ds_read_b128 v[40:43], v14 offset:35840
    v_mfma_f32_16x16x32_bf16 v[64:67], v[24:27], v[32:35], v[64:67]
    ds_read_b128 v[48:51], v15 offset:35840
    v_mfma_f32_16x16x32_bf16 v[68:71], v[24:27], v[36:39], v[68:71]
    ds_read_b128 v[44:47], v14 offset:39936
    v_mfma_f32_16x16x32_bf16 v[72:75], v[28:31], v[32:35], v[72:75]
    ds_read_b128 v[52:55], v15 offset:39936
    v_mfma_f32_16x16x32_bf16 v[76:79], v[28:31], v[36:39], v[76:79]
    s_waitcnt lgkmcnt(0)
    v_mfma_f32_16x16x32_bf16 v[64:67], v[40:43], v[48:51], v[64:67]
    v_mfma_f32_16x16x32_bf16 v[68:71], v[40:43], v[52:55], v[68:71]
    v_mfma_f32_16x16x32_bf16 v[72:75], v[44:47], v[48:51], v[72:75]
    v_mfma_f32_16x16x32_bf16 v[76:79], v[44:47], v[52:55], v[76:79]
    s_waitcnt vmcnt(0)
    s_nop 3
    v_cvt_pk_bf16_f32 v40, v64, v65
    v_lshlrev_b32 v41, 16, v40
    v_and_b32 v40, s15, v40
    v_lshlrev_b32 v42, 16, v16
    v_and_b32 v43, s15, v16
    v_add_f32 v41, v41, v42
    v_add_f32 v40, v40, v43
    v_cvt_pk_bf16_f32 v24, v41, v40
    v_cvt_pk_bf16_f32 v40, v66, v67
    v_lshlrev_b32 v41, 16, v40
    v_and_b32 v40, s15, v40
    v_lshlrev_b32 v42, 16, v17
    v_and_b32 v43, s15, v17
    v_add_f32 v41, v41, v42
    v_add_f32 v40, v40, v43
    v_cvt_pk_bf16_f32 v25, v41, v40
    v_cvt_pk_bf16_f32 v40, v72, v73
    v_lshlrev_b32 v41, 16, v40
    v_and_b32 v40, s15, v40
    v_lshlrev_b32 v42, 16, v18
    v_and_b32 v43, s15, v18
    v_add_f32 v41, v41, v42
    v_add_f32 v40, v40, v43
    v_cvt_pk_bf16_f32 v26, v41, v40
    v_cvt_pk_bf16_f32 v40, v74, v75
    v_lshlrev_b32 v41, 16, v40
    v_and_b32 v40, s15, v40
    v_lshlrev_b32 v42, 16, v19
    v_and_b32 v43, s15, v19
    v_add_f32 v41, v41, v42
    v_add_f32 v40, v40, v43
    v_cvt_pk_bf16_f32 v27, v41, v40
    global_store_dwordx4 v8, v[24:27], s[34:35] sc1
    v_cvt_pk_bf16_f32 v40, v68, v69
    v_lshlrev_b32 v41, 16, v40
    v_and_b32 v40, s15, v40
    v_lshlrev_b32 v42, 16, v20
    v_and_b32 v43, s15, v20
    v_add_f32 v41, v41, v42
    v_add_f32 v40, v40, v43
    v_cvt_pk_bf16_f32 v28, v41, v40
    v_cvt_pk_bf16_f32 v40, v70, v71
    v_lshlrev_b32 v41, 16, v40
    v_and_b32 v40, s15, v40
    v_lshlrev_b32 v42, 16, v21
    v_and_b32 v43, s15, v21
    v_add_f32 v41, v41, v42
    v_add_f32 v40, v40, v43
    v_cvt_pk_bf16_f32 v29, v41, v40
    v_cvt_pk_bf16_f32 v40, v76, v77
    v_lshlrev_b32 v41, 16, v40
    v_and_b32 v40, s15, v40
    v_lshlrev_b32 v42, 16, v22
    v_and_b32 v43, s15, v22
    v_add_f32 v41, v41, v42
    v_add_f32 v40, v40, v43
    v_cvt_pk_bf16_f32 v30, v41, v40
    v_cvt_pk_bf16_f32 v40, v78, v79
    v_lshlrev_b32 v41, 16, v40
    v_and_b32 v40, s15, v40
    v_lshlrev_b32 v42, 16, v23
    v_and_b32 v43, s15, v23
    v_add_f32 v41, v41, v42
    v_add_f32 v40, v40, v43
    v_cvt_pk_bf16_f32 v31, v41, v40
    global_store_dwordx4 v9, v[28:31], s[34:35] sc1
    s_endpgm
K4_LD:
    s_sub_u32 s3, s3, 4
    s_lshl_b32 s6, s5, 2
    s_add_u32 s6, s6, s3
    s_mul_i32 s6, s6, 57344
    s_add_u32 s6, s6, 18874368
    v_add_u32 v5, s6, v7
    s_lshl_b32 s6, s4, 2
    s_add_u32 s6, s6, s3
    s_mul_i32 s6, s6, 57344
    s_add_u32 s6, s6, 8388608
    v_add_u32 v6, s6, v7
    s_lshl_b32 s12, s3, 12
    s_add_u32 s13, s12, 16384
    s_waitcnt lgkmcnt(0)
    s_mov_b32 s36, s32
    s_mov_b32 s37, s33
    s_mov_b32 s38, 20480000
    s_mov_b32 s39, 0x00020000
    s_mov_b32 s14, 0
    s_add_u32 m0, s12, 0
    s_nop 0
    buffer_load_dwordx4 v5, s[36:39], s14 offen offset:0 lds
    buffer_load_dwordx4 v5, s[36:39], s14 offen offset:1024 lds
    buffer_load_dwordx4 v5, s[36:39], s14 offen offset:2048 lds
    buffer_load_dwordx4 v5, s[36:39], s14 offen offset:3072 lds
    s_add_u32 m0, s13, 0
    s_nop 0
    buffer_load_dwordx4 v6, s[36:39], s14 offen offset:0 lds
    buffer_load_dwordx4 v6, s[36:39], s14 offen offset:1024 lds
    buffer_load_dwordx4 v6, s[36:39], s14 offen offset:2048 lds
    buffer_load_dwordx4 v6, s[36:39], s14 offen offset:3072 lds
    s_mov_b32 s14, 4096
    s_add_u32 m0, s12, 32768
    s_nop 0
    buffer_load_dwordx4 v5, s[36:39], s14 offen offset:0 lds
    buffer_load_dwordx4 v5, s[36:39], s14 offen offset:1024 lds
    buffer_load_dwordx4 v5, s[36:39], s14 offen offset:2048 lds
    buffer_load_dwordx4 v5, s[36:39], s14 offen offset:3072 lds
    s_add_u32 m0, s13, 32768
    s_nop 0
    buffer_load_dwordx4 v6, s[36:39], s14 offen offset:0 lds
    buffer_load_dwordx4 v6, s[36:39], s14 offen offset:1024 lds
    buffer_load_dwordx4 v6, s[36:39], s14 offen offset:2048 lds
    buffer_load_dwordx4 v6, s[36:39], s14 offen offset:3072 lds
    s_waitcnt vmcnt(8)
    s_barrier
    s_mov_b32 s14, 8192
    s_add_u32 m0, s12, 65536
    s_nop 0
    buffer_load_dwordx4 v5, s[36:39], s14 offen offset:0 lds
    buffer_load_dwordx4 v5, s[36:39], s14 offen offset:1024 lds
    buffer_load_dwordx4 v5, s[36:39], s14 offen offset:2048 lds
    buffer_load_dwordx4 v5, s[36:39], s14 offen offset:3072 lds
    s_add_u32 m0, s13, 65536
    s_nop 0
    buffer_load_dwordx4 v6, s[36:39], s14 offen offset:0 lds
    buffer_load_dwordx4 v6, s[36:39], s14 offen offset:1024 lds
    buffer_load_dwordx4 v6, s[36:39], s14 offen offset:2048 lds
    buffer_load_dwordx4 v6, s[36:39], s14 offen offset:3072 lds
    s_mov_b32 s14, 12288
    s_add_u32 m0, s12, 98304
    s_nop 0
    buffer_load_dwordx4 v5, s[36:39], s14 offen offset:0 lds
    buffer_load_dwordx4 v5, s[36:39], s14 offen offset:1024 lds
    buffer_load_dwordx4 v5, s[36:39], s14 offen offset:2048 lds
    buffer_load_dwordx4 v5, s[36:39], s14 offen offset:3072 lds
    s_add_u32 m0, s13, 98304
    s_nop 0
    buffer_load_dwordx4 v6, s[36:39], s14 offen offset:0 lds
    buffer_load_dwordx4 v6, s[36:39], s14 offen offset:1024 lds
    buffer_load_dwordx4 v6, s[36:39], s14 offen offset:2048 lds
    buffer_load_dwordx4 v6, s[36:39], s14 offen offset:3072 lds
    s_waitcnt vmcnt(16)
    s_barrier
    s_mov_b32 s14, 16384
    s_add_u32 m0, s12, 131072
    s_nop 0
    buffer_load_dwordx4 v5, s[36:39], s14 offen offset:0 lds
    buffer_load_dwordx4 v5, s[36:39], s14 offen offset:1024 lds
    buffer_load_dwordx4 v5, s[36:39], s14 offen offset:2048 lds
    buffer_load_dwordx4 v5, s[36:39], s14 offen offset:3072 lds
    s_add_u32 m0, s13, 131072
    s_nop 0
    buffer_load_dwordx4 v6, s[36:39], s14 offen offset:0 lds
    buffer_load_dwordx4 v6, s[36:39], s14 offen offset:1024 lds
    buffer_load_dwordx4 v6, s[36:39], s14 offen offset:2048 lds
    buffer_load_dwordx4 v6, s[36:39], s14 offen offset:3072 lds
    s_mov_b32 s14, 20480
    s_add_u32 m0, s12, 0
    s_nop 0
    buffer_load_dwordx4 v5, s[36:39], s14 offen offset:0 lds
    buffer_load_dwordx4 v5, s[36:39], s14 offen offset:1024 lds
    buffer_load_dwordx4 v5, s[36:39], s14 offen offset:2048 lds
    buffer_load_dwordx4 v5, s[36:39], s14 offen offset:3072 lds
    s_add_u32 m0, s13, 0
    s_nop 0
    buffer_load_dwordx4 v6, s[36:39], s14 offen offset:0 lds
    buffer_load_dwordx4 v6, s[36:39], s14 offen offset:1024 lds
    buffer_load_dwordx4 v6, s[36:39], s14 offen offset:2048 lds
    buffer_load_dwordx4 v6, s[36:39], s14 offen offset:3072 lds
    s_waitcnt vmcnt(24)
    s_barrier
    s_mov_b32 s14, 24576
    s_add_u32 m0, s12, 32768
    s_nop 0
    buffer_load_dwordx4 v5, s[36:39], s14 offen offset:0 lds
    buffer_load_dwordx4 v5, s[36:39], s14 offen offset:1024 lds
    buffer_load_dwordx4 v5, s[36:39], s14 offen offset:2048 lds
    buffer_load_dwordx4 v5, s[36:39], s14 offen offset:3072 lds
    s_add_u32 m0, s13, 32768
    s_nop 0
    buffer_load_dwordx4 v6, s[36:39], s14 offen offset:0 lds
    buffer_load_dwordx4 v6, s[36:39], s14 offen offset:1024 lds
    buffer_load_dwordx4 v6, s[36:39], s14 offen offset:2048 lds
    buffer_load_dwordx4 v6, s[36:39], s14 offen offset:3072 lds
    s_waitcnt vmcnt(24)
    s_barrier
    s_mov_b32 s14, 28672
    s_add_u32 m0, s12, 65536
    s_nop 0
    buffer_load_dwordx4 v5, s[36:39], s14 offen offset:0 lds
    buffer_load_dwordx4 v5, s[36:39], s14 offen offset:1024 lds
    buffer_load_dwordx4 v5, s[36:39], s14 offen offset:2048 lds
    buffer_load_dwordx4 v5, s[36:39], s14 offen offset:3072 lds
    s_add_u32 m0, s13, 65536
    s_nop 0
    buffer_load_dwordx4 v6, s[36:39], s14 offen offset:0 lds
    buffer_load_dwordx4 v6, s[36:39], s14 offen offset:1024 lds
    buffer_load_dwordx4 v6, s[36:39], s14 offen offset:2048 lds
    buffer_load_dwordx4 v6, s[36:39], s14 offen offset:3072 lds
    s_waitcnt vmcnt(24)
    s_barrier
    s_mov_b32 s14, 32768
    s_add_u32 m0, s12, 98304
    s_nop 0
    buffer_load_dwordx4 v5, s[36:39], s14 offen offset:0 lds
    buffer_load_dwordx4 v5, s[36:39], s14 offen offset:1024 lds
    buffer_load_dwordx4 v5, s[36:39], s14 offen offset:2048 lds
    buffer_load_dwordx4 v5, s[36:39], s14 offen offset:3072 lds
    s_add_u32 m0, s13, 98304
    s_nop 0
    buffer_load_dwordx4 v6, s[36:39], s14 offen offset:0 lds
    buffer_load_dwordx4 v6, s[36:39], s14 offen offset:1024 lds
    buffer_load_dwordx4 v6, s[36:39], s14 offen offset:2048 lds
    buffer_load_dwordx4 v6, s[36:39], s14 offen offset:3072 lds
    s_waitcnt vmcnt(24)
    s_barrier
    s_mov_b32 s14, 36864
    s_add_u32 m0, s12, 131072
    s_nop 0
    buffer_load_dwordx4 v5, s[36:39], s14 offen offset:0 lds
    buffer_load_dwordx4 v5, s[36:39], s14 offen offset:1024 lds
    buffer_load_dwordx4 v5, s[36:39], s14 offen offset:2048 lds
    buffer_load_dwordx4 v5, s[36:39], s14 offen offset:3072 lds
    s_add_u32 m0, s13, 131072
    s_nop 0
    buffer_load_dwordx4 v6, s[36:39], s14 offen offset:0 lds
    buffer_load_dwordx4 v6, s[36:39], s14 offen offset:1024 lds
    buffer_load_dwordx4 v6, s[36:39], s14 offen offset:2048 lds
    buffer_load_dwordx4 v6, s[36:39], s14 offen offset:3072 lds
    s_waitcnt vmcnt(24)
    s_barrier
    s_mov_b32 s14, 40960
    s_add_u32 m0, s12, 0
    s_nop 0
    buffer_load_dwordx4 v5, s[36:39], s14 offen offset:0 lds
    buffer_load_dwordx4 v5, s[36:39], s14 offen offset:1024 lds
    buffer_load_dwordx4 v5, s[36:39], s14 offen offset:2048 lds
    buffer_load_dwordx4 v5, s[36:39], s14 offen offset:3072 lds
    s_add_u32 m0, s13, 0
    s_nop 0
    buffer_load_dwordx4 v6, s[36:39], s14 offen offset:0 lds
    buffer_load_dwordx4 v6, s[36:39], s14 offen offset:1024 lds
    buffer_load_dwordx4 v6, s[36:39], s14 offen offset:2048 lds
    buffer_load_dwordx4 v6, s[36:39], s14 offen offset:3072 lds
    s_waitcnt vmcnt(24)
    s_barrier
    s_mov_b32 s14, 45056
    s_add_u32 m0, s12, 32768
    s_nop 0
    buffer_load_dwordx4 v5, s[36:39], s14 offen offset:0 lds
    buffer_load_dwordx4 v5, s[36:39], s14 offen offset:1024 lds
    buffer_load_dwordx4 v5, s[36:39], s14 offen offset:2048 lds
    buffer_load_dwordx4 v5, s[36:39], s14 offen offset:3072 lds
    s_add_u32 m0, s13, 32768
    s_nop 0
    buffer_load_dwordx4 v6, s[36:39], s14 offen offset:0 lds
    buffer_load_dwordx4 v6, s[36:39], s14 offen offset:1024 lds
    buffer_load_dwordx4 v6, s[36:39], s14 offen offset:2048 lds
    buffer_load_dwordx4 v6, s[36:39], s14 offen offset:3072 lds
    s_waitcnt vmcnt(24)
    s_barrier
    s_mov_b32 s14, 49152
    s_add_u32 m0, s12, 65536
    s_nop 0
    buffer_load_dwordx4 v5, s[36:39], s14 offen offset:0 lds
    buffer_load_dwordx4 v5, s[36:39], s14 offen offset:1024 lds
    buffer_load_dwordx4 v5, s[36:39], s14 offen offset:2048 lds
    buffer_load_dwordx4 v5, s[36:39], s14 offen offset:3072 lds
    s_add_u32 m0, s13, 65536
    s_nop 0
    buffer_load_dwordx4 v6, s[36:39], s14 offen offset:0 lds
    buffer_load_dwordx4 v6, s[36:39], s14 offen offset:1024 lds
    buffer_load_dwordx4 v6, s[36:39], s14 offen offset:2048 lds
    buffer_load_dwordx4 v6, s[36:39], s14 offen offset:3072 lds
    s_waitcnt vmcnt(24)
    s_barrier
    s_mov_b32 s14, 53248
    s_add_u32 m0, s12, 98304
    s_nop 0
    buffer_load_dwordx4 v5, s[36:39], s14 offen offset:0 lds
    buffer_load_dwordx4 v5, s[36:39], s14 offen offset:1024 lds
    buffer_load_dwordx4 v5, s[36:39], s14 offen offset:2048 lds
    buffer_load_dwordx4 v5, s[36:39], s14 offen offset:3072 lds
    s_add_u32 m0, s13, 98304
    s_nop 0
    buffer_load_dwordx4 v6, s[36:39], s14 offen offset:0 lds
    buffer_load_dwordx4 v6, s[36:39], s14 offen offset:1024 lds
    buffer_load_dwordx4 v6, s[36:39], s14 offen offset:2048 lds
    buffer_load_dwordx4 v6, s[36:39], s14 offen offset:3072 lds
    s_waitcnt vmcnt(24)
    s_barrier
    s_waitcnt vmcnt(16)
    s_barrier
    s_waitcnt vmcnt(8)
    s_barrier
    s_waitcnt vmcnt(0)
    s_barrier
    s_endpgm
K4_PF:
    s_and_b32 s4, s2, 7
    s_lshl_b32 s4, s4, 2
    s_sub_u32 s5, s2, 224
    s_lshr_b32 s5, s5, 3
    s_add_u32 s4, s4, s5
    s_lshl_b32 s4, s4, 2
    s_and_b32 s5, s3, 3
    s_add_u32 s4, s4, s5
    s_mul_i32 s4, s4, 57344
    s_lshr_b32 s5, s3, 2
    s_mul_i32 s5, s5, 18432
    s_add_u32 s4, s4, s5
    s_add_u32 s4, s4, 8409088
    v_lshlrev_b32 v7, 4, v2
    v_add_u32 v7, s4, v7
    s_waitcnt lgkmcnt(0)
    global_load_dwordx4 v[8:11], v7, s[32:33] offset:0
    global_load_dwordx4 v[12:15], v7, s[32:33] offset:1024
    global_load_dwordx4 v[16:19], v7, s[32:33] offset:2048
    global_load_dwordx4 v[20:23], v7, s[32:33] offset:3072
    v_add_u32 v7, 4096, v7
    global_load_dwordx4 v[24:27], v7, s[32:33] offset:0
    global_load_dwordx4 v[28:31], v7, s[32:33] offset:1024
    global_load_dwordx4 v[32:35], v7, s[32:33] offset:2048
    global_load_dwordx4 v[36:39], v7, s[32:33] offset:3072
    v_add_u32 v7, 4096, v7
    global_load_dwordx4 v[40:43], v7, s[32:33] offset:0
    global_load_dwordx4 v[44:47], v7, s[32:33] offset:1024
    global_load_dwordx4 v[48:51], v7, s[32:33] offset:2048
    global_load_dwordx4 v[52:55], v7, s[32:33] offset:3072
    v_add_u32 v7, 4096, v7
    global_load_dwordx4 v[56:59], v7, s[32:33] offset:0
    global_load_dwordx4 v[60:63], v7, s[32:33] offset:1024
    global_load_dwordx4 v[64:67], v7, s[32:33] offset:2048
    global_load_dwordx4 v[68:71], v7, s[32:33] offset:3072
    v_add_u32 v7, 4096, v7
    global_load_dwordx4 v[72:75], v7, s[32:33] offset:0
    global_load_dwordx4 v[76:79], v7, s[32:33] offset:1024
K4_END:
    s_endpgm
.section .rodata,"a"
.p2align 6
.amdhsa_kernel k4_kernel
  .amdhsa_next_free_vgpr 96
  .amdhsa_next_free_sgpr 48
  .amdhsa_accum_offset 96
  .amdhsa_group_segment_fixed_size 0
  .amdhsa_kernarg_size 120
  .amdhsa_user_sgpr_count 2
  .amdhsa_user_sgpr_kernarg_segment_ptr 1
  .amdhsa_system_sgpr_workgroup_id_x 1
.end_amdhsa_kernel
.text
```
